```python
import torch

def _softmax(x, axis=-1):
    return torch.softmax(x, dim=axis)
def _gelu(x):
    return torch.nn.functional.gelu(x, approximate="tanh")
def _silu(x):
    return torch.nn.functional.silu(x)
def _sigmoid(x):
    return torch.sigmoid(x)
def _layernorm(x, axis=-1, eps=1e-5):
    m = x.mean(dim=axis, keepdim=True)
    v = x.var(dim=axis, keepdim=True, unbiased=False)
    return (x - m) / torch.sqrt(v + eps)
def _scatter_add(tgt, idx, src, axis=0):
    return tgt.clone().index_add_(axis, idx, src)
def _segment_sum(src, seg, n):
    out = torch.zeros((n,) + src.shape[1:], dtype=src.dtype)
    return out.index_add_(0, seg, src)
def _pad(x, pw):
    flat = tuple(v for pair in reversed(pw) for v in pair)
    return torch.nn.functional.pad(x, flat)

kernel_name = 'standalone__gqa_softmax__near_ridge'

def setup_inputs():

    _w = (lambda a: (lambda t: t.to(torch.bfloat16) if t.is_floating_point() else t)(torch.as_tensor(a)))
    B, Hq, Hkv, Sq, Sk, D = 16, 32, 8, 496, 512, 128
    return {
        "q": _w((lambda *s: torch.randn(*s, dtype=torch.bfloat16) * 0.8)(B, Hq, Sq, D)),
        "k": _w((lambda *s: torch.randn(*s, dtype=torch.bfloat16) * 0.8)(B, Hkv, Sk, D)),
        "v": _w((lambda *s: torch.randn(*s, dtype=torch.bfloat16) * 0.05)(B, Hkv, Sk, D)),
    }

def reference(q, k, v):
    B, Hq, Sq, D = q.shape
    Hkv = k.shape[1]
    rep = Hq // Hkv
    k = (lambda x, n, axis: torch.repeat_interleave(x, n, dim=axis))(k, rep, axis=1)
    v = (lambda x, n, axis: torch.repeat_interleave(x, n, dim=axis))(v, rep, axis=1)
    scale = D ** -0.5
    scores = torch.einsum("bhqd,bhkd->bhqk", q, k) * scale
    p = _softmax(scores, axis=-1)
    return torch.einsum("bhqk,bhkd->bhqd", p, v)
```

```asm
; @launch grid=(256,1,1) block=(256,1,1) lds=163840
.amdgcn_target "amdgcn-amd-amdhsa--gfx950"
.text
.globl standalone__gqa_softmax__near_ridge_kernel
.p2align 8
.type standalone__gqa_softmax__near_ridge_kernel,@function
standalone__gqa_softmax__near_ridge_kernel:
  s_cmp_ge_u32 s2, 256
  s_cbranch_scc1 L_end
  s_load_dwordx8 s[36:43], s[0:1], 0
  v_lshrrev_b32 v248, 6, v0
  v_and_b32 v249, 63, v0
  v_readfirstlane_b32 s20, v248
  v_lshrrev_b32 v252, 4, v249
  v_and_b32 v253, 15, v249
  s_and_b32 s48, s2, 7
  s_lshr_b32 s49, s2, 4
  s_lshl_b32 s49, s49, 3
  s_add_u32 s48, s48, s49
  s_lshl_b32 s52, s48, 17
  v_add_u32 v254, 0, v252
  v_xor_b32 v254, v254, v253
  v_lshlrev_b32 v254, 4, v254
  v_lshl_add_u32 v160, v252, 8, v254
  v_add_u32 v254, 4, v252
  v_xor_b32 v254, v254, v253
  v_lshlrev_b32 v254, 4, v254
  v_lshl_add_u32 v161, v252, 8, v254
  v_add_u32 v254, 8, v252
  v_xor_b32 v254, v254, v253
  v_lshlrev_b32 v254, 4, v254
  v_lshl_add_u32 v162, v252, 8, v254
  v_add_u32 v254, 12, v252
  v_xor_b32 v254, v254, v253
  v_lshlrev_b32 v254, 4, v254
  v_lshl_add_u32 v163, v252, 8, v254
  s_lshl_b32 s53, s20, 15
  s_add_u32 s54, s53, 32768
  s_mov_b32 s10, 131072
  s_mov_b32 s11, 0x00020000
  s_lshr_b32 s49, s2, 3
  s_and_b32 s49, s49, 1
  s_lshl_b32 s50, s48, 1
  s_add_u32 s50, s50, s49
  s_mul_i32 s51, s50, 253952
  s_lshl_b32 s56, s20, 3
  s_lshl_b32 s57, s20, 11
  v_add_u32 v254, s56, v252
  v_and_b32 v254, 15, v254
  v_xor_b32 v254, v254, v253
  v_lshlrev_b32 v254, 4, v254
  v_lshl_add_u32 v254, v252, 8, v254
  v_add_u32 v231, s57, v254
  v_add_u32 v254, s56, v252
  v_add_u32 v254, 4, v254
  v_and_b32 v254, 15, v254
  v_xor_b32 v254, v254, v253
  v_lshlrev_b32 v254, 4, v254
  v_lshl_add_u32 v254, v252, 8, v254
  v_add_u32 v232, s57, v254
  s_add_u32 s24, s57, 0
  s_mov_b32 s21, 0
  s_waitcnt lgkmcnt(0)
  s_add_u32 s8, s38, s52
  s_addc_u32 s9, s39, 0
  s_add_u32 m0, s54, 0
  s_add_u32 s55, s53, 0
  buffer_load_dwordx4 v160, s[8:11], s55 offen nt lds
  buffer_load_dwordx4 v161, s[8:11], s55 offen offset:1024 nt lds
  buffer_load_dwordx4 v162, s[8:11], s55 offen offset:2048 nt lds
  buffer_load_dwordx4 v163, s[8:11], s55 offen offset:3072 nt lds
  s_add_u32 m0, s54, 4096
  s_add_u32 s55, s53, 4096
  buffer_load_dwordx4 v160, s[8:11], s55 offen nt lds
  buffer_load_dwordx4 v161, s[8:11], s55 offen offset:1024 nt lds
  buffer_load_dwordx4 v162, s[8:11], s55 offen offset:2048 nt lds
  buffer_load_dwordx4 v163, s[8:11], s55 offen offset:3072 nt lds
  s_add_u32 m0, s54, 8192
  s_add_u32 s55, s53, 8192
  buffer_load_dwordx4 v160, s[8:11], s55 offen nt lds
  buffer_load_dwordx4 v161, s[8:11], s55 offen offset:1024 nt lds
  buffer_load_dwordx4 v162, s[8:11], s55 offen offset:2048 nt lds
  buffer_load_dwordx4 v163, s[8:11], s55 offen offset:3072 nt lds
  s_add_u32 m0, s54, 12288
  s_add_u32 s55, s53, 12288
  buffer_load_dwordx4 v160, s[8:11], s55 offen nt lds
  buffer_load_dwordx4 v161, s[8:11], s55 offen offset:1024 nt lds
  buffer_load_dwordx4 v162, s[8:11], s55 offen offset:2048 nt lds
  buffer_load_dwordx4 v163, s[8:11], s55 offen offset:3072 nt lds
  s_add_u32 m0, s54, 16384
  s_add_u32 s55, s53, 16384
  buffer_load_dwordx4 v160, s[8:11], s55 offen nt lds
  buffer_load_dwordx4 v161, s[8:11], s55 offen offset:1024 nt lds
  buffer_load_dwordx4 v162, s[8:11], s55 offen offset:2048 nt lds
  buffer_load_dwordx4 v163, s[8:11], s55 offen offset:3072 nt lds
  s_add_u32 m0, s54, 20480
  s_add_u32 s55, s53, 20480
  buffer_load_dwordx4 v160, s[8:11], s55 offen nt lds
  buffer_load_dwordx4 v161, s[8:11], s55 offen offset:1024 nt lds
  buffer_load_dwordx4 v162, s[8:11], s55 offen offset:2048 nt lds
  buffer_load_dwordx4 v163, s[8:11], s55 offen offset:3072 nt lds
  s_add_u32 m0, s54, 24576
  s_add_u32 s55, s53, 24576
  buffer_load_dwordx4 v160, s[8:11], s55 offen nt lds
  buffer_load_dwordx4 v161, s[8:11], s55 offen offset:1024 nt lds
  buffer_load_dwordx4 v162, s[8:11], s55 offen offset:2048 nt lds
  buffer_load_dwordx4 v163, s[8:11], s55 offen offset:3072 nt lds
  s_add_u32 m0, s54, 28672
  s_add_u32 s55, s53, 28672
  buffer_load_dwordx4 v160, s[8:11], s55 offen nt lds
  buffer_load_dwordx4 v161, s[8:11], s55 offen offset:1024 nt lds
  buffer_load_dwordx4 v162, s[8:11], s55 offen offset:2048 nt lds
  buffer_load_dwordx4 v163, s[8:11], s55 offen offset:3072 nt lds
  s_add_u32 s4, s36, s51
  s_addc_u32 s5, s37, 0
  s_mov_b32 s6, 253952
  s_mov_b32 s7, 0x00020000
  s_add_u32 m0, s24, 0
  s_nop 0
  buffer_load_dwordx4 v231, s[4:7], s21 offen nt lds
  buffer_load_dwordx4 v232, s[4:7], s21 offen offset:1024 nt lds
  s_add_u32 s21, s21, 8192
  s_add_u32 m0, s24, 8192
  s_nop 0
  buffer_load_dwordx4 v231, s[4:7], s21 offen nt lds
  buffer_load_dwordx4 v232, s[4:7], s21 offen offset:1024 nt lds
  s_add_u32 s21, s21, 8192
  s_add_u32 m0, s24, 16384
  s_nop 0
  buffer_load_dwordx4 v231, s[4:7], s21 offen nt lds
  buffer_load_dwordx4 v232, s[4:7], s21 offen offset:1024 nt lds
  s_add_u32 s21, s21, 8192
  s_add_u32 s12, s40, s52
  s_addc_u32 s13, s41, 0
  s_mov_b32 s14, 131072
  s_mov_b32 s15, 0x00020000
  s_add_u32 s16, s42, s51
  s_addc_u32 s17, s43, 0
  s_mov_b32 s18, 253952
  s_mov_b32 s19, 0x00020000
  s_mov_b32 s32, 0x3e0293ee
  s_mov_b32 s33, 0x3e0293ee
  s_mov_b32 s34, 0x67800000
  s_mov_b32 s35, 0x6b800000
  s_mov_b32 s60, 0xffff0000
  v_and_b32 v250, 31, v249
  v_lshrrev_b32 v251, 5, v249
  v_and_b32 v254, 15, v250
  v_xor_b32 v254, v254, v251
  v_lshlrev_b32 v254, 4, v254
  v_lshl_add_u32 v216, v250, 8, v254
  v_xor_b32 v217, 32, v216
  v_xor_b32 v218, 64, v216
  v_xor_b32 v219, 96, v216
  v_xor_b32 v220, 128, v216
  v_xor_b32 v221, 160, v216
  v_xor_b32 v222, 192, v216
  v_xor_b32 v223, 224, v216
  v_add_u32 v172, s53, v216
  v_add_u32 v173, s53, v217
  v_add_u32 v174, s53, v218
  v_add_u32 v175, s53, v219
  v_add_u32 v176, s53, v220
  v_add_u32 v177, s53, v221
  v_add_u32 v178, s53, v222
  v_add_u32 v179, s53, v223
  v_lshlrev_b32 v254, 2, v252
  v_xor_b32 v254, v254, v253
  v_lshlrev_b32 v254, 4, v254
  v_lshl_add_u32 v164, v252, 8, v254
  s_lshl_b32 s56, s20, 6
  v_lshlrev_b32 v254, 4, v251
  v_lshl_add_u32 v254, v250, 8, v254
  v_add_u32 v230, s56, v254
  s_lshl_b32 s57, s20, 2
  v_add_u32 v254, s57, v251
  v_and_b32 v255, 7, v250
  v_xor_b32 v254, v254, v255
  v_lshlrev_b32 v254, 4, v254
  v_lshl_add_u32 v244, v250, 8, v254
  v_add_u32 v244, 100352, v244
  v_xor_b32 v245, 32, v244
  s_lshl_b32 s57, s20, 11
  v_xor_b32 v254, v253, v252
  v_lshlrev_b32 v254, 4, v254
  v_lshl_add_u32 v254, v252, 8, v254
  v_add_u32 v246, s57, v254
  v_add_u32 v246, 100352, v246
  v_add_u32 v247, 0x400, v246
  v_xor_b32 v247, 64, v247
  v_lshlrev_b32 v254, 4, v249
  v_add_u32 v248, s57, v254
  s_lshl_b32 s56, s20, 13
  v_lshlrev_b32 v254, 4, v249
  v_add_u32 v255, 32768, v254
  v_add_u32 v224, s56, v255
  s_add_u32 s57, s20, 1
  s_and_b32 s57, s57, 3
  s_lshl_b32 s57, s57, 13
  v_add_u32 v225, s57, v255
  s_add_u32 s57, s20, 2
  s_and_b32 s57, s57, 3
  s_lshl_b32 s57, s57, 13
  v_add_u32 v226, s57, v255
  s_add_u32 s57, s20, 3
  s_and_b32 s57, s57, 3
  s_lshl_b32 s57, s57, 13
  v_add_u32 v227, s57, v255
  s_lshl_b32 s56, s20, 2
  v_lshlrev_b32 v254, 4, v250
  v_add_u32 v229, 98304, v254
  v_add_u32 v228, s56, v229
  s_mov_b32 s22, 0
  v_mov_b32 v243, 0
  v_lshrrev_b32 v254, 1, v252
  v_lshlrev_b32 v254, 2, v254
  v_lshrrev_b32 v255, 2, v253
  v_add_u32 v254, v254, v255
  v_lshlrev_b32 v254, 8, v254
  v_xor_b32 v255, s20, v255
  v_lshl_add_u32 v254, v255, 6, v254
  v_and_b32 v255, 1, v252
  v_lshl_add_u32 v254, v255, 5, v254
  v_and_b32 v255, 1, v253
  v_lshl_add_u32 v254, v255, 4, v254
  v_bfe_u32 v255, v253, 1, 1
  v_lshl_add_u32 v254, v255, 3, v254
  s_add_u32 s57, s20, 0
  s_and_b32 s57, s57, 3
  s_lshl_b32 s57, s57, 15
  v_add_u32 v168, s57, v254
  s_add_u32 s57, s20, 1
  s_and_b32 s57, s57, 3
  s_lshl_b32 s57, s57, 15
  v_add_u32 v169, s57, v254
  s_add_u32 s57, s20, 2
  s_and_b32 s57, s57, 3
  s_lshl_b32 s57, s57, 15
  v_add_u32 v170, s57, v254
  s_add_u32 s57, s20, 3
  s_and_b32 s57, s57, 3
  s_lshl_b32 s57, s57, 15
  v_add_u32 v171, s57, v254
  v_mov_b32 v249, s34
  s_waitcnt vmcnt(30)
  ds_read_b128 v[0:3], v172 offset:32768
  ds_read_b128 v[4:7], v173 offset:32768
  ds_read_b128 v[8:11], v174 offset:32768
  ds_read_b128 v[12:15], v175 offset:32768
  ds_read_b128 v[16:19], v176 offset:32768
  ds_read_b128 v[20:23], v177 offset:32768
  ds_read_b128 v[24:27], v178 offset:32768
  ds_read_b128 v[28:31], v179 offset:32768
  s_waitcnt vmcnt(22)
  ds_read_b128 v[32:35], v172 offset:40960
  ds_read_b128 v[36:39], v173 offset:40960
  ds_read_b128 v[40:43], v174 offset:40960
  ds_read_b128 v[44:47], v175 offset:40960
  ds_read_b128 v[48:51], v176 offset:40960
  ds_read_b128 v[52:55], v177 offset:40960
  ds_read_b128 v[56:59], v178 offset:40960
  ds_read_b128 v[60:63], v179 offset:40960
  s_waitcnt vmcnt(14)
  ds_read_b128 v[64:67], v172 offset:49152
  ds_read_b128 v[68:71], v173 offset:49152
  ds_read_b128 v[72:75], v174 offset:49152
  ds_read_b128 v[76:79], v175 offset:49152
  ds_read_b128 v[80:83], v176 offset:49152
  ds_read_b128 v[84:87], v177 offset:49152
  ds_read_b128 v[88:91], v178 offset:49152
  ds_read_b128 v[92:95], v179 offset:49152
  s_waitcnt vmcnt(6)
  ds_read_b128 v[96:99], v172 offset:57344
  ds_read_b128 v[100:103], v173 offset:57344
  ds_read_b128 v[104:107], v174 offset:57344
  ds_read_b128 v[108:111], v175 offset:57344
  ds_read_b128 v[112:115], v176 offset:57344
  ds_read_b128 v[116:119], v177 offset:57344
  ds_read_b128 v[120:123], v178 offset:57344
  ds_read_b128 v[124:127], v179 offset:57344
  s_waitcnt lgkmcnt(0)
  s_add_u32 m0, s54, 0
  s_add_u32 s55, s53, 0
  buffer_load_dwordx4 v164, s[12:15], s55 offen nt lds
  v_lshlrev_b32 v128, 16, v0
  v_and_b32 v129, s60, v0
  v_pk_mul_f32 v[128:129], v[128:129], s[32:33]
  v_cvt_pk_bf16_f32 v0, v128, v129
  v_accvgpr_write_b32 a0, v0
  v_lshlrev_b32 v130, 16, v1
  v_and_b32 v131, s60, v1
  v_pk_mul_f32 v[130:131], v[130:131], s[32:33]
  v_cvt_pk_bf16_f32 v1, v130, v131
  v_accvgpr_write_b32 a1, v1
  v_lshlrev_b32 v132, 16, v2
  v_and_b32 v133, s60, v2
  v_pk_mul_f32 v[132:133], v[132:133], s[32:33]
  v_cvt_pk_bf16_f32 v2, v132, v133
  v_accvgpr_write_b32 a2, v2
  v_lshlrev_b32 v134, 16, v3
  v_and_b32 v135, s60, v3
  v_pk_mul_f32 v[134:135], v[134:135], s[32:33]
  v_cvt_pk_bf16_f32 v3, v134, v135
  v_accvgpr_write_b32 a3, v3
  v_lshlrev_b32 v136, 16, v4
  v_and_b32 v137, s60, v4
  v_pk_mul_f32 v[136:137], v[136:137], s[32:33]
  v_cvt_pk_bf16_f32 v4, v136, v137
  v_accvgpr_write_b32 a4, v4
  v_lshlrev_b32 v138, 16, v5
  v_and_b32 v139, s60, v5
  v_pk_mul_f32 v[138:139], v[138:139], s[32:33]
  v_cvt_pk_bf16_f32 v5, v138, v139
  v_accvgpr_write_b32 a5, v5
  v_lshlrev_b32 v140, 16, v6
  v_and_b32 v141, s60, v6
  v_pk_mul_f32 v[140:141], v[140:141], s[32:33]
  v_cvt_pk_bf16_f32 v6, v140, v141
  v_accvgpr_write_b32 a6, v6
  v_lshlrev_b32 v142, 16, v7
  v_and_b32 v143, s60, v7
  v_pk_mul_f32 v[142:143], v[142:143], s[32:33]
  v_cvt_pk_bf16_f32 v7, v142, v143
  v_accvgpr_write_b32 a7, v7
  buffer_load_dwordx4 v164, s[12:15], s55 offen offset:1024 nt lds
  v_lshlrev_b32 v128, 16, v8
  v_and_b32 v129, s60, v8
  v_pk_mul_f32 v[128:129], v[128:129], s[32:33]
  v_cvt_pk_bf16_f32 v8, v128, v129
  v_accvgpr_write_b32 a8, v8
  v_lshlrev_b32 v130, 16, v9
  v_and_b32 v131, s60, v9
  v_pk_mul_f32 v[130:131], v[130:131], s[32:33]
  v_cvt_pk_bf16_f32 v9, v130, v131
  v_accvgpr_write_b32 a9, v9
  v_lshlrev_b32 v132, 16, v10
  v_and_b32 v133, s60, v10
  v_pk_mul_f32 v[132:133], v[132:133], s[32:33]
  v_cvt_pk_bf16_f32 v10, v132, v133
  v_accvgpr_write_b32 a10, v10
  v_lshlrev_b32 v134, 16, v11
  v_and_b32 v135, s60, v11
  v_pk_mul_f32 v[134:135], v[134:135], s[32:33]
  v_cvt_pk_bf16_f32 v11, v134, v135
  v_accvgpr_write_b32 a11, v11
  v_lshlrev_b32 v136, 16, v12
  v_and_b32 v137, s60, v12
  v_pk_mul_f32 v[136:137], v[136:137], s[32:33]
  v_cvt_pk_bf16_f32 v12, v136, v137
  v_accvgpr_write_b32 a12, v12
  v_lshlrev_b32 v138, 16, v13
  v_and_b32 v139, s60, v13
  v_pk_mul_f32 v[138:139], v[138:139], s[32:33]
  v_cvt_pk_bf16_f32 v13, v138, v139
  v_accvgpr_write_b32 a13, v13
  v_lshlrev_b32 v140, 16, v14
  v_and_b32 v141, s60, v14
  v_pk_mul_f32 v[140:141], v[140:141], s[32:33]
  v_cvt_pk_bf16_f32 v14, v140, v141
  v_accvgpr_write_b32 a14, v14
  v_lshlrev_b32 v142, 16, v15
  v_and_b32 v143, s60, v15
  v_pk_mul_f32 v[142:143], v[142:143], s[32:33]
  v_cvt_pk_bf16_f32 v15, v142, v143
  v_accvgpr_write_b32 a15, v15
  buffer_load_dwordx4 v164, s[12:15], s55 offen offset:2048 nt lds
  v_lshlrev_b32 v128, 16, v16
  v_and_b32 v129, s60, v16
  v_pk_mul_f32 v[128:129], v[128:129], s[32:33]
  v_cvt_pk_bf16_f32 v16, v128, v129
  v_accvgpr_write_b32 a16, v16
  v_lshlrev_b32 v130, 16, v17
  v_and_b32 v131, s60, v17
  v_pk_mul_f32 v[130:131], v[130:131], s[32:33]
  v_cvt_pk_bf16_f32 v17, v130, v131
  v_accvgpr_write_b32 a17, v17
  v_lshlrev_b32 v132, 16, v18
  v_and_b32 v133, s60, v18
  v_pk_mul_f32 v[132:133], v[132:133], s[32:33]
  v_cvt_pk_bf16_f32 v18, v132, v133
  v_accvgpr_write_b32 a18, v18
  v_lshlrev_b32 v134, 16, v19
  v_and_b32 v135, s60, v19
  v_pk_mul_f32 v[134:135], v[134:135], s[32:33]
  v_cvt_pk_bf16_f32 v19, v134, v135
  v_accvgpr_write_b32 a19, v19
  v_lshlrev_b32 v136, 16, v20
  v_and_b32 v137, s60, v20
  v_pk_mul_f32 v[136:137], v[136:137], s[32:33]
  v_cvt_pk_bf16_f32 v20, v136, v137
  v_accvgpr_write_b32 a20, v20
  v_lshlrev_b32 v138, 16, v21
  v_and_b32 v139, s60, v21
  v_pk_mul_f32 v[138:139], v[138:139], s[32:33]
  v_cvt_pk_bf16_f32 v21, v138, v139
  v_accvgpr_write_b32 a21, v21
  v_lshlrev_b32 v140, 16, v22
  v_and_b32 v141, s60, v22
  v_pk_mul_f32 v[140:141], v[140:141], s[32:33]
  v_cvt_pk_bf16_f32 v22, v140, v141
  v_accvgpr_write_b32 a22, v22
  v_lshlrev_b32 v142, 16, v23
  v_and_b32 v143, s60, v23
  v_pk_mul_f32 v[142:143], v[142:143], s[32:33]
  v_cvt_pk_bf16_f32 v23, v142, v143
  v_accvgpr_write_b32 a23, v23
  buffer_load_dwordx4 v164, s[12:15], s55 offen offset:3072 nt lds
  v_lshlrev_b32 v128, 16, v24
  v_and_b32 v129, s60, v24
  v_pk_mul_f32 v[128:129], v[128:129], s[32:33]
  v_cvt_pk_bf16_f32 v24, v128, v129
  v_accvgpr_write_b32 a24, v24
  v_lshlrev_b32 v130, 16, v25
  v_and_b32 v131, s60, v25
  v_pk_mul_f32 v[130:131], v[130:131], s[32:33]
  v_cvt_pk_bf16_f32 v25, v130, v131
  v_accvgpr_write_b32 a25, v25
  v_lshlrev_b32 v132, 16, v26
  v_and_b32 v133, s60, v26
  v_pk_mul_f32 v[132:133], v[132:133], s[32:33]
  v_cvt_pk_bf16_f32 v26, v132, v133
  v_accvgpr_write_b32 a26, v26
  v_lshlrev_b32 v134, 16, v27
  v_and_b32 v135, s60, v27
  v_pk_mul_f32 v[134:135], v[134:135], s[32:33]
  v_cvt_pk_bf16_f32 v27, v134, v135
  v_accvgpr_write_b32 a27, v27
  v_lshlrev_b32 v136, 16, v28
  v_and_b32 v137, s60, v28
  v_pk_mul_f32 v[136:137], v[136:137], s[32:33]
  v_cvt_pk_bf16_f32 v28, v136, v137
  v_accvgpr_write_b32 a28, v28
  v_lshlrev_b32 v138, 16, v29
  v_and_b32 v139, s60, v29
  v_pk_mul_f32 v[138:139], v[138:139], s[32:33]
  v_cvt_pk_bf16_f32 v29, v138, v139
  v_accvgpr_write_b32 a29, v29
  v_lshlrev_b32 v140, 16, v30
  v_and_b32 v141, s60, v30
  v_pk_mul_f32 v[140:141], v[140:141], s[32:33]
  v_cvt_pk_bf16_f32 v30, v140, v141
  v_accvgpr_write_b32 a30, v30
  v_lshlrev_b32 v142, 16, v31
  v_and_b32 v143, s60, v31
  v_pk_mul_f32 v[142:143], v[142:143], s[32:33]
  v_cvt_pk_bf16_f32 v31, v142, v143
  v_accvgpr_write_b32 a31, v31
  s_add_u32 m0, s54, 4096
  s_add_u32 s55, s53, 4096
  buffer_load_dwordx4 v164, s[12:15], s55 offen nt lds
  v_lshlrev_b32 v128, 16, v32
  v_and_b32 v129, s60, v32
  v_pk_mul_f32 v[128:129], v[128:129], s[32:33]
  v_cvt_pk_bf16_f32 v32, v128, v129
  v_accvgpr_write_b32 a32, v32
  v_lshlrev_b32 v130, 16, v33
  v_and_b32 v131, s60, v33
  v_pk_mul_f32 v[130:131], v[130:131], s[32:33]
  v_cvt_pk_bf16_f32 v33, v130, v131
  v_accvgpr_write_b32 a33, v33
  v_lshlrev_b32 v132, 16, v34
  v_and_b32 v133, s60, v34
  v_pk_mul_f32 v[132:133], v[132:133], s[32:33]
  v_cvt_pk_bf16_f32 v34, v132, v133
  v_accvgpr_write_b32 a34, v34
  v_lshlrev_b32 v134, 16, v35
  v_and_b32 v135, s60, v35
  v_pk_mul_f32 v[134:135], v[134:135], s[32:33]
  v_cvt_pk_bf16_f32 v35, v134, v135
  v_accvgpr_write_b32 a35, v35
  v_lshlrev_b32 v136, 16, v36
  v_and_b32 v137, s60, v36
  v_pk_mul_f32 v[136:137], v[136:137], s[32:33]
  v_cvt_pk_bf16_f32 v36, v136, v137
  v_accvgpr_write_b32 a36, v36
  v_lshlrev_b32 v138, 16, v37
  v_and_b32 v139, s60, v37
  v_pk_mul_f32 v[138:139], v[138:139], s[32:33]
  v_cvt_pk_bf16_f32 v37, v138, v139
  v_accvgpr_write_b32 a37, v37
  v_lshlrev_b32 v140, 16, v38
  v_and_b32 v141, s60, v38
  v_pk_mul_f32 v[140:141], v[140:141], s[32:33]
  v_cvt_pk_bf16_f32 v38, v140, v141
  v_accvgpr_write_b32 a38, v38
  v_lshlrev_b32 v142, 16, v39
  v_and_b32 v143, s60, v39
  v_pk_mul_f32 v[142:143], v[142:143], s[32:33]
  v_cvt_pk_bf16_f32 v39, v142, v143
  v_accvgpr_write_b32 a39, v39
  buffer_load_dwordx4 v164, s[12:15], s55 offen offset:1024 nt lds
  v_lshlrev_b32 v128, 16, v40
  v_and_b32 v129, s60, v40
  v_pk_mul_f32 v[128:129], v[128:129], s[32:33]
  v_cvt_pk_bf16_f32 v40, v128, v129
  v_accvgpr_write_b32 a40, v40
  v_lshlrev_b32 v130, 16, v41
  v_and_b32 v131, s60, v41
  v_pk_mul_f32 v[130:131], v[130:131], s[32:33]
  v_cvt_pk_bf16_f32 v41, v130, v131
  v_accvgpr_write_b32 a41, v41
  v_lshlrev_b32 v132, 16, v42
  v_and_b32 v133, s60, v42
  v_pk_mul_f32 v[132:133], v[132:133], s[32:33]
  v_cvt_pk_bf16_f32 v42, v132, v133
  v_accvgpr_write_b32 a42, v42
  v_lshlrev_b32 v134, 16, v43
  v_and_b32 v135, s60, v43
  v_pk_mul_f32 v[134:135], v[134:135], s[32:33]
  v_cvt_pk_bf16_f32 v43, v134, v135
  v_accvgpr_write_b32 a43, v43
  v_lshlrev_b32 v136, 16, v44
  v_and_b32 v137, s60, v44
  v_pk_mul_f32 v[136:137], v[136:137], s[32:33]
  v_cvt_pk_bf16_f32 v44, v136, v137
  v_accvgpr_write_b32 a44, v44
  v_lshlrev_b32 v138, 16, v45
  v_and_b32 v139, s60, v45
  v_pk_mul_f32 v[138:139], v[138:139], s[32:33]
  v_cvt_pk_bf16_f32 v45, v138, v139
  v_accvgpr_write_b32 a45, v45
  v_lshlrev_b32 v140, 16, v46
  v_and_b32 v141, s60, v46
  v_pk_mul_f32 v[140:141], v[140:141], s[32:33]
  v_cvt_pk_bf16_f32 v46, v140, v141
  v_accvgpr_write_b32 a46, v46
  v_lshlrev_b32 v142, 16, v47
  v_and_b32 v143, s60, v47
  v_pk_mul_f32 v[142:143], v[142:143], s[32:33]
  v_cvt_pk_bf16_f32 v47, v142, v143
  v_accvgpr_write_b32 a47, v47
  buffer_load_dwordx4 v164, s[12:15], s55 offen offset:2048 nt lds
  v_lshlrev_b32 v128, 16, v48
  v_and_b32 v129, s60, v48
  v_pk_mul_f32 v[128:129], v[128:129], s[32:33]
  v_cvt_pk_bf16_f32 v48, v128, v129
  v_accvgpr_write_b32 a48, v48
  v_lshlrev_b32 v130, 16, v49
  v_and_b32 v131, s60, v49
  v_pk_mul_f32 v[130:131], v[130:131], s[32:33]
  v_cvt_pk_bf16_f32 v49, v130, v131
  v_accvgpr_write_b32 a49, v49
  v_lshlrev_b32 v132, 16, v50
  v_and_b32 v133, s60, v50
  v_pk_mul_f32 v[132:133], v[132:133], s[32:33]
  v_cvt_pk_bf16_f32 v50, v132, v133
  v_accvgpr_write_b32 a50, v50
  v_lshlrev_b32 v134, 16, v51
  v_and_b32 v135, s60, v51
  v_pk_mul_f32 v[134:135], v[134:135], s[32:33]
  v_cvt_pk_bf16_f32 v51, v134, v135
  v_accvgpr_write_b32 a51, v51
  v_lshlrev_b32 v136, 16, v52
  v_and_b32 v137, s60, v52
  v_pk_mul_f32 v[136:137], v[136:137], s[32:33]
  v_cvt_pk_bf16_f32 v52, v136, v137
  v_accvgpr_write_b32 a52, v52
  v_lshlrev_b32 v138, 16, v53
  v_and_b32 v139, s60, v53
  v_pk_mul_f32 v[138:139], v[138:139], s[32:33]
  v_cvt_pk_bf16_f32 v53, v138, v139
  v_accvgpr_write_b32 a53, v53
  v_lshlrev_b32 v140, 16, v54
  v_and_b32 v141, s60, v54
  v_pk_mul_f32 v[140:141], v[140:141], s[32:33]
  v_cvt_pk_bf16_f32 v54, v140, v141
  v_accvgpr_write_b32 a54, v54
  v_lshlrev_b32 v142, 16, v55
  v_and_b32 v143, s60, v55
  v_pk_mul_f32 v[142:143], v[142:143], s[32:33]
  v_cvt_pk_bf16_f32 v55, v142, v143
  v_accvgpr_write_b32 a55, v55
  buffer_load_dwordx4 v164, s[12:15], s55 offen offset:3072 nt lds
  v_lshlrev_b32 v128, 16, v56
  v_and_b32 v129, s60, v56
  v_pk_mul_f32 v[128:129], v[128:129], s[32:33]
  v_cvt_pk_bf16_f32 v56, v128, v129
  v_accvgpr_write_b32 a56, v56
  v_lshlrev_b32 v130, 16, v57
  v_and_b32 v131, s60, v57
  v_pk_mul_f32 v[130:131], v[130:131], s[32:33]
  v_cvt_pk_bf16_f32 v57, v130, v131
  v_accvgpr_write_b32 a57, v57
  v_lshlrev_b32 v132, 16, v58
  v_and_b32 v133, s60, v58
  v_pk_mul_f32 v[132:133], v[132:133], s[32:33]
  v_cvt_pk_bf16_f32 v58, v132, v133
  v_accvgpr_write_b32 a58, v58
  v_lshlrev_b32 v134, 16, v59
  v_and_b32 v135, s60, v59
  v_pk_mul_f32 v[134:135], v[134:135], s[32:33]
  v_cvt_pk_bf16_f32 v59, v134, v135
  v_accvgpr_write_b32 a59, v59
  v_lshlrev_b32 v136, 16, v60
  v_and_b32 v137, s60, v60
  v_pk_mul_f32 v[136:137], v[136:137], s[32:33]
  v_cvt_pk_bf16_f32 v60, v136, v137
  v_accvgpr_write_b32 a60, v60
  v_lshlrev_b32 v138, 16, v61
  v_and_b32 v139, s60, v61
  v_pk_mul_f32 v[138:139], v[138:139], s[32:33]
  v_cvt_pk_bf16_f32 v61, v138, v139
  v_accvgpr_write_b32 a61, v61
  v_lshlrev_b32 v140, 16, v62
  v_and_b32 v141, s60, v62
  v_pk_mul_f32 v[140:141], v[140:141], s[32:33]
  v_cvt_pk_bf16_f32 v62, v140, v141
  v_accvgpr_write_b32 a62, v62
  v_lshlrev_b32 v142, 16, v63
  v_and_b32 v143, s60, v63
  v_pk_mul_f32 v[142:143], v[142:143], s[32:33]
  v_cvt_pk_bf16_f32 v63, v142, v143
  v_accvgpr_write_b32 a63, v63
  s_add_u32 m0, s54, 8192
  s_add_u32 s55, s53, 8192
  buffer_load_dwordx4 v164, s[12:15], s55 offen nt lds
  v_lshlrev_b32 v128, 16, v64
  v_and_b32 v129, s60, v64
  v_pk_mul_f32 v[128:129], v[128:129], s[32:33]
  v_cvt_pk_bf16_f32 v64, v128, v129
  v_accvgpr_write_b32 a64, v64
  v_lshlrev_b32 v130, 16, v65
  v_and_b32 v131, s60, v65
  v_pk_mul_f32 v[130:131], v[130:131], s[32:33]
  v_cvt_pk_bf16_f32 v65, v130, v131
  v_accvgpr_write_b32 a65, v65
  v_lshlrev_b32 v132, 16, v66
  v_and_b32 v133, s60, v66
  v_pk_mul_f32 v[132:133], v[132:133], s[32:33]
  v_cvt_pk_bf16_f32 v66, v132, v133
  v_accvgpr_write_b32 a66, v66
  v_lshlrev_b32 v134, 16, v67
  v_and_b32 v135, s60, v67
  v_pk_mul_f32 v[134:135], v[134:135], s[32:33]
  v_cvt_pk_bf16_f32 v67, v134, v135
  v_accvgpr_write_b32 a67, v67
  v_lshlrev_b32 v136, 16, v68
  v_and_b32 v137, s60, v68
  v_pk_mul_f32 v[136:137], v[136:137], s[32:33]
  v_cvt_pk_bf16_f32 v68, v136, v137
  v_accvgpr_write_b32 a68, v68
  v_lshlrev_b32 v138, 16, v69
  v_and_b32 v139, s60, v69
  v_pk_mul_f32 v[138:139], v[138:139], s[32:33]
  v_cvt_pk_bf16_f32 v69, v138, v139
  v_accvgpr_write_b32 a69, v69
  v_lshlrev_b32 v140, 16, v70
  v_and_b32 v141, s60, v70
  v_pk_mul_f32 v[140:141], v[140:141], s[32:33]
  v_cvt_pk_bf16_f32 v70, v140, v141
  v_accvgpr_write_b32 a70, v70
  v_lshlrev_b32 v142, 16, v71
  v_and_b32 v143, s60, v71
  v_pk_mul_f32 v[142:143], v[142:143], s[32:33]
  v_cvt_pk_bf16_f32 v71, v142, v143
  v_accvgpr_write_b32 a71, v71
  buffer_load_dwordx4 v164, s[12:15], s55 offen offset:1024 nt lds
  v_lshlrev_b32 v128, 16, v72
  v_and_b32 v129, s60, v72
  v_pk_mul_f32 v[128:129], v[128:129], s[32:33]
  v_cvt_pk_bf16_f32 v72, v128, v129
  v_accvgpr_write_b32 a72, v72
  v_lshlrev_b32 v130, 16, v73
  v_and_b32 v131, s60, v73
  v_pk_mul_f32 v[130:131], v[130:131], s[32:33]
  v_cvt_pk_bf16_f32 v73, v130, v131
  v_accvgpr_write_b32 a73, v73
  v_lshlrev_b32 v132, 16, v74
  v_and_b32 v133, s60, v74
  v_pk_mul_f32 v[132:133], v[132:133], s[32:33]
  v_cvt_pk_bf16_f32 v74, v132, v133
  v_accvgpr_write_b32 a74, v74
  v_lshlrev_b32 v134, 16, v75
  v_and_b32 v135, s60, v75
  v_pk_mul_f32 v[134:135], v[134:135], s[32:33]
  v_cvt_pk_bf16_f32 v75, v134, v135
  v_accvgpr_write_b32 a75, v75
  v_lshlrev_b32 v136, 16, v76
  v_and_b32 v137, s60, v76
  v_pk_mul_f32 v[136:137], v[136:137], s[32:33]
  v_cvt_pk_bf16_f32 v76, v136, v137
  v_accvgpr_write_b32 a76, v76
  v_lshlrev_b32 v138, 16, v77
  v_and_b32 v139, s60, v77
  v_pk_mul_f32 v[138:139], v[138:139], s[32:33]
  v_cvt_pk_bf16_f32 v77, v138, v139
  v_accvgpr_write_b32 a77, v77
  v_lshlrev_b32 v140, 16, v78
  v_and_b32 v141, s60, v78
  v_pk_mul_f32 v[140:141], v[140:141], s[32:33]
  v_cvt_pk_bf16_f32 v78, v140, v141
  v_accvgpr_write_b32 a78, v78
  v_lshlrev_b32 v142, 16, v79
  v_and_b32 v143, s60, v79
  v_pk_mul_f32 v[142:143], v[142:143], s[32:33]
  v_cvt_pk_bf16_f32 v79, v142, v143
  v_accvgpr_write_b32 a79, v79
  buffer_load_dwordx4 v164, s[12:15], s55 offen offset:2048 nt lds
  v_lshlrev_b32 v128, 16, v80
  v_and_b32 v129, s60, v80
  v_pk_mul_f32 v[128:129], v[128:129], s[32:33]
  v_cvt_pk_bf16_f32 v80, v128, v129
  v_accvgpr_write_b32 a80, v80
  v_lshlrev_b32 v130, 16, v81
  v_and_b32 v131, s60, v81
  v_pk_mul_f32 v[130:131], v[130:131], s[32:33]
  v_cvt_pk_bf16_f32 v81, v130, v131
  v_accvgpr_write_b32 a81, v81
  v_lshlrev_b32 v132, 16, v82
  v_and_b32 v133, s60, v82
  v_pk_mul_f32 v[132:133], v[132:133], s[32:33]
  v_cvt_pk_bf16_f32 v82, v132, v133
  v_accvgpr_write_b32 a82, v82
  v_lshlrev_b32 v134, 16, v83
  v_and_b32 v135, s60, v83
  v_pk_mul_f32 v[134:135], v[134:135], s[32:33]
  v_cvt_pk_bf16_f32 v83, v134, v135
  v_accvgpr_write_b32 a83, v83
  v_lshlrev_b32 v136, 16, v84
  v_and_b32 v137, s60, v84
  v_pk_mul_f32 v[136:137], v[136:137], s[32:33]
  v_cvt_pk_bf16_f32 v84, v136, v137
  v_accvgpr_write_b32 a84, v84
  v_lshlrev_b32 v138, 16, v85
  v_and_b32 v139, s60, v85
  v_pk_mul_f32 v[138:139], v[138:139], s[32:33]
  v_cvt_pk_bf16_f32 v85, v138, v139
  v_accvgpr_write_b32 a85, v85
  v_lshlrev_b32 v140, 16, v86
  v_and_b32 v141, s60, v86
  v_pk_mul_f32 v[140:141], v[140:141], s[32:33]
  v_cvt_pk_bf16_f32 v86, v140, v141
  v_accvgpr_write_b32 a86, v86
  v_lshlrev_b32 v142, 16, v87
  v_and_b32 v143, s60, v87
  v_pk_mul_f32 v[142:143], v[142:143], s[32:33]
  v_cvt_pk_bf16_f32 v87, v142, v143
  v_accvgpr_write_b32 a87, v87
  buffer_load_dwordx4 v164, s[12:15], s55 offen offset:3072 nt lds
  v_lshlrev_b32 v128, 16, v88
  v_and_b32 v129, s60, v88
  v_pk_mul_f32 v[128:129], v[128:129], s[32:33]
  v_cvt_pk_bf16_f32 v88, v128, v129
  v_accvgpr_write_b32 a88, v88
  v_lshlrev_b32 v130, 16, v89
  v_and_b32 v131, s60, v89
  v_pk_mul_f32 v[130:131], v[130:131], s[32:33]
  v_cvt_pk_bf16_f32 v89, v130, v131
  v_accvgpr_write_b32 a89, v89
  v_lshlrev_b32 v132, 16, v90
  v_and_b32 v133, s60, v90
  v_pk_mul_f32 v[132:133], v[132:133], s[32:33]
  v_cvt_pk_bf16_f32 v90, v132, v133
  v_accvgpr_write_b32 a90, v90
  v_lshlrev_b32 v134, 16, v91
  v_and_b32 v135, s60, v91
  v_pk_mul_f32 v[134:135], v[134:135], s[32:33]
  v_cvt_pk_bf16_f32 v91, v134, v135
  v_accvgpr_write_b32 a91, v91
  v_lshlrev_b32 v136, 16, v92
  v_and_b32 v137, s60, v92
  v_pk_mul_f32 v[136:137], v[136:137], s[32:33]
  v_cvt_pk_bf16_f32 v92, v136, v137
  v_accvgpr_write_b32 a92, v92
  v_lshlrev_b32 v138, 16, v93
  v_and_b32 v139, s60, v93
  v_pk_mul_f32 v[138:139], v[138:139], s[32:33]
  v_cvt_pk_bf16_f32 v93, v138, v139
  v_accvgpr_write_b32 a93, v93
  v_lshlrev_b32 v140, 16, v94
  v_and_b32 v141, s60, v94
  v_pk_mul_f32 v[140:141], v[140:141], s[32:33]
  v_cvt_pk_bf16_f32 v94, v140, v141
  v_accvgpr_write_b32 a94, v94
  v_lshlrev_b32 v142, 16, v95
  v_and_b32 v143, s60, v95
  v_pk_mul_f32 v[142:143], v[142:143], s[32:33]
  v_cvt_pk_bf16_f32 v95, v142, v143
  v_accvgpr_write_b32 a95, v95
  s_add_u32 m0, s54, 12288
  s_add_u32 s55, s53, 12288
  buffer_load_dwordx4 v164, s[12:15], s55 offen nt lds
  v_lshlrev_b32 v128, 16, v96
  v_and_b32 v129, s60, v96
  v_pk_mul_f32 v[128:129], v[128:129], s[32:33]
  v_cvt_pk_bf16_f32 v96, v128, v129
  v_accvgpr_write_b32 a96, v96
  v_lshlrev_b32 v130, 16, v97
  v_and_b32 v131, s60, v97
  v_pk_mul_f32 v[130:131], v[130:131], s[32:33]
  v_cvt_pk_bf16_f32 v97, v130, v131
  v_accvgpr_write_b32 a97, v97
  v_lshlrev_b32 v132, 16, v98
  v_and_b32 v133, s60, v98
  v_pk_mul_f32 v[132:133], v[132:133], s[32:33]
  v_cvt_pk_bf16_f32 v98, v132, v133
  v_accvgpr_write_b32 a98, v98
  v_lshlrev_b32 v134, 16, v99
  v_and_b32 v135, s60, v99
  v_pk_mul_f32 v[134:135], v[134:135], s[32:33]
  v_cvt_pk_bf16_f32 v99, v134, v135
  v_accvgpr_write_b32 a99, v99
  v_lshlrev_b32 v136, 16, v100
  v_and_b32 v137, s60, v100
  v_pk_mul_f32 v[136:137], v[136:137], s[32:33]
  v_cvt_pk_bf16_f32 v100, v136, v137
  v_accvgpr_write_b32 a100, v100
  v_lshlrev_b32 v138, 16, v101
  v_and_b32 v139, s60, v101
  v_pk_mul_f32 v[138:139], v[138:139], s[32:33]
  v_cvt_pk_bf16_f32 v101, v138, v139
  v_accvgpr_write_b32 a101, v101
  v_lshlrev_b32 v140, 16, v102
  v_and_b32 v141, s60, v102
  v_pk_mul_f32 v[140:141], v[140:141], s[32:33]
  v_cvt_pk_bf16_f32 v102, v140, v141
  v_accvgpr_write_b32 a102, v102
  v_lshlrev_b32 v142, 16, v103
  v_and_b32 v143, s60, v103
  v_pk_mul_f32 v[142:143], v[142:143], s[32:33]
  v_cvt_pk_bf16_f32 v103, v142, v143
  v_accvgpr_write_b32 a103, v103
  buffer_load_dwordx4 v164, s[12:15], s55 offen offset:1024 nt lds
  v_lshlrev_b32 v128, 16, v104
  v_and_b32 v129, s60, v104
  v_pk_mul_f32 v[128:129], v[128:129], s[32:33]
  v_cvt_pk_bf16_f32 v104, v128, v129
  v_accvgpr_write_b32 a104, v104
  v_lshlrev_b32 v130, 16, v105
  v_and_b32 v131, s60, v105
  v_pk_mul_f32 v[130:131], v[130:131], s[32:33]
  v_cvt_pk_bf16_f32 v105, v130, v131
  v_accvgpr_write_b32 a105, v105
  v_lshlrev_b32 v132, 16, v106
  v_and_b32 v133, s60, v106
  v_pk_mul_f32 v[132:133], v[132:133], s[32:33]
  v_cvt_pk_bf16_f32 v106, v132, v133
  v_accvgpr_write_b32 a106, v106
  v_lshlrev_b32 v134, 16, v107
  v_and_b32 v135, s60, v107
  v_pk_mul_f32 v[134:135], v[134:135], s[32:33]
  v_cvt_pk_bf16_f32 v107, v134, v135
  v_accvgpr_write_b32 a107, v107
  v_lshlrev_b32 v136, 16, v108
  v_and_b32 v137, s60, v108
  v_pk_mul_f32 v[136:137], v[136:137], s[32:33]
  v_cvt_pk_bf16_f32 v108, v136, v137
  v_accvgpr_write_b32 a108, v108
  v_lshlrev_b32 v138, 16, v109
  v_and_b32 v139, s60, v109
  v_pk_mul_f32 v[138:139], v[138:139], s[32:33]
  v_cvt_pk_bf16_f32 v109, v138, v139
  v_accvgpr_write_b32 a109, v109
  v_lshlrev_b32 v140, 16, v110
  v_and_b32 v141, s60, v110
  v_pk_mul_f32 v[140:141], v[140:141], s[32:33]
  v_cvt_pk_bf16_f32 v110, v140, v141
  v_accvgpr_write_b32 a110, v110
  v_lshlrev_b32 v142, 16, v111
  v_and_b32 v143, s60, v111
  v_pk_mul_f32 v[142:143], v[142:143], s[32:33]
  v_cvt_pk_bf16_f32 v111, v142, v143
  v_accvgpr_write_b32 a111, v111
  buffer_load_dwordx4 v164, s[12:15], s55 offen offset:2048 nt lds
  v_lshlrev_b32 v128, 16, v112
  v_and_b32 v129, s60, v112
  v_pk_mul_f32 v[128:129], v[128:129], s[32:33]
  v_cvt_pk_bf16_f32 v112, v128, v129
  v_accvgpr_write_b32 a112, v112
  v_lshlrev_b32 v130, 16, v113
  v_and_b32 v131, s60, v113
  v_pk_mul_f32 v[130:131], v[130:131], s[32:33]
  v_cvt_pk_bf16_f32 v113, v130, v131
  v_accvgpr_write_b32 a113, v113
  v_lshlrev_b32 v132, 16, v114
  v_and_b32 v133, s60, v114
  v_pk_mul_f32 v[132:133], v[132:133], s[32:33]
  v_cvt_pk_bf16_f32 v114, v132, v133
  v_accvgpr_write_b32 a114, v114
  v_lshlrev_b32 v134, 16, v115
  v_and_b32 v135, s60, v115
  v_pk_mul_f32 v[134:135], v[134:135], s[32:33]
  v_cvt_pk_bf16_f32 v115, v134, v135
  v_accvgpr_write_b32 a115, v115
  v_lshlrev_b32 v136, 16, v116
  v_and_b32 v137, s60, v116
  v_pk_mul_f32 v[136:137], v[136:137], s[32:33]
  v_cvt_pk_bf16_f32 v116, v136, v137
  v_accvgpr_write_b32 a116, v116
  v_lshlrev_b32 v138, 16, v117
  v_and_b32 v139, s60, v117
  v_pk_mul_f32 v[138:139], v[138:139], s[32:33]
  v_cvt_pk_bf16_f32 v117, v138, v139
  v_accvgpr_write_b32 a117, v117
  v_lshlrev_b32 v140, 16, v118
  v_and_b32 v141, s60, v118
  v_pk_mul_f32 v[140:141], v[140:141], s[32:33]
  v_cvt_pk_bf16_f32 v118, v140, v141
  v_accvgpr_write_b32 a118, v118
  v_lshlrev_b32 v142, 16, v119
  v_and_b32 v143, s60, v119
  v_pk_mul_f32 v[142:143], v[142:143], s[32:33]
  v_cvt_pk_bf16_f32 v119, v142, v143
  v_accvgpr_write_b32 a119, v119
  buffer_load_dwordx4 v164, s[12:15], s55 offen offset:3072 nt lds
  v_lshlrev_b32 v128, 16, v120
  v_and_b32 v129, s60, v120
  v_pk_mul_f32 v[128:129], v[128:129], s[32:33]
  v_cvt_pk_bf16_f32 v120, v128, v129
  v_accvgpr_write_b32 a120, v120
  v_lshlrev_b32 v130, 16, v121
  v_and_b32 v131, s60, v121
  v_pk_mul_f32 v[130:131], v[130:131], s[32:33]
  v_cvt_pk_bf16_f32 v121, v130, v131
  v_accvgpr_write_b32 a121, v121
  v_lshlrev_b32 v132, 16, v122
  v_and_b32 v133, s60, v122
  v_pk_mul_f32 v[132:133], v[132:133], s[32:33]
  v_cvt_pk_bf16_f32 v122, v132, v133
  v_accvgpr_write_b32 a122, v122
  v_lshlrev_b32 v134, 16, v123
  v_and_b32 v135, s60, v123
  v_pk_mul_f32 v[134:135], v[134:135], s[32:33]
  v_cvt_pk_bf16_f32 v123, v134, v135
  v_accvgpr_write_b32 a123, v123
  v_lshlrev_b32 v136, 16, v124
  v_and_b32 v137, s60, v124
  v_pk_mul_f32 v[136:137], v[136:137], s[32:33]
  v_cvt_pk_bf16_f32 v124, v136, v137
  v_accvgpr_write_b32 a124, v124
  v_lshlrev_b32 v138, 16, v125
  v_and_b32 v139, s60, v125
  v_pk_mul_f32 v[138:139], v[138:139], s[32:33]
  v_cvt_pk_bf16_f32 v125, v138, v139
  v_accvgpr_write_b32 a125, v125
  v_lshlrev_b32 v140, 16, v126
  v_and_b32 v141, s60, v126
  v_pk_mul_f32 v[140:141], v[140:141], s[32:33]
  v_cvt_pk_bf16_f32 v126, v140, v141
  v_accvgpr_write_b32 a126, v126
  v_lshlrev_b32 v142, 16, v127
  v_and_b32 v143, s60, v127
  v_pk_mul_f32 v[142:143], v[142:143], s[32:33]
  v_cvt_pk_bf16_f32 v127, v142, v143
  v_accvgpr_write_b32 a127, v127
  s_waitcnt vmcnt(16)
  s_barrier
  ds_read_b128 v[128:131], v216 offset:0
  ds_read_b128 v[132:135], v217 offset:0
  ds_read_b128 v[136:139], v218 offset:0
  ds_read_b128 v[140:143], v219 offset:0
  ds_read_b128 v[144:147], v220 offset:0
  ds_read_b128 v[148:151], v221 offset:0
  ds_read_b128 v[152:155], v222 offset:0
  ds_read_b128 v[156:159], v223 offset:0
  s_waitcnt lgkmcnt(7)
  v_mfma_f32_32x32x16_bf16 v[0:15], a[0:3], v[128:131], 0
  s_waitcnt lgkmcnt(6)
  v_mfma_f32_32x32x16_bf16 v[0:15], a[4:7], v[132:135], v[0:15]
  s_add_u32 m0, s54, 16384
  s_add_u32 s55, s53, 16384
  buffer_load_dwordx4 v164, s[12:15], s55 offen nt lds
  s_waitcnt lgkmcnt(5)
  v_mfma_f32_32x32x16_bf16 v[0:15], a[8:11], v[136:139], v[0:15]
  s_waitcnt lgkmcnt(4)
  v_mfma_f32_32x32x16_bf16 v[0:15], a[12:15], v[140:143], v[0:15]
  s_waitcnt lgkmcnt(3)
  v_mfma_f32_32x32x16_bf16 v[0:15], a[16:19], v[144:147], v[0:15]
  s_waitcnt lgkmcnt(2)
  v_mfma_f32_32x32x16_bf16 v[0:15], a[20:23], v[148:151], v[0:15]
  buffer_load_dwordx4 v164, s[12:15], s55 offen offset:1024 nt lds
  s_waitcnt lgkmcnt(1)
  v_mfma_f32_32x32x16_bf16 v[0:15], a[24:27], v[152:155], v[0:15]
  s_waitcnt lgkmcnt(0)
  v_mfma_f32_32x32x16_bf16 v[0:15], a[28:31], v[156:159], v[0:15]
  v_mfma_f32_32x32x16_bf16 v[16:31], a[32:35], v[128:131], 0
  v_mfma_f32_32x32x16_bf16 v[16:31], a[36:39], v[132:135], v[16:31]
  buffer_load_dwordx4 v164, s[12:15], s55 offen offset:2048 nt lds
  v_mfma_f32_32x32x16_bf16 v[16:31], a[40:43], v[136:139], v[16:31]
  s_nop 7
  v_exp_f32 v0, v0
  v_exp_f32 v1, v1
  v_mfma_f32_32x32x16_bf16 v[16:31], a[44:47], v[140:143], v[16:31]
  v_exp_f32 v2, v2
  v_exp_f32 v3, v3
  v_add_f32 v233, v0, v1
  v_mfma_f32_32x32x16_bf16 v[16:31], a[48:51], v[144:147], v[16:31]
  v_cvt_pk_bf16_f32 v0, v0, v1
  v_mfma_f32_32x32x16_bf16 v[16:31], a[52:55], v[148:151], v[16:31]
  buffer_load_dwordx4 v164, s[12:15], s55 offen offset:3072 nt lds
  v_exp_f32 v4, v4
  v_exp_f32 v5, v5
  v_add_f32 v233, v233, v2
  v_add_f32 v233, v233, v3
  v_mfma_f32_32x32x16_bf16 v[16:31], a[56:59], v[152:155], v[16:31]
  v_cvt_pk_bf16_f32 v1, v2, v3
  v_exp_f32 v6, v6
  v_exp_f32 v7, v7
  v_add_f32 v233, v233, v4
  v_mfma_f32_32x32x16_bf16 v[16:31], a[60:63], v[156:159], v[16:31]
  s_barrier
  v_add_f32 v233, v233, v5
  v_mfma_f32_32x32x16_bf16 v[32:47], a[64:67], v[128:131], 0
  v_cvt_pk_bf16_f32 v2, v4, v5
  v_mfma_f32_32x32x16_bf16 v[32:47], a[68:71], v[132:135], v[32:47]
  s_add_u32 m0, s54, 20480
  s_add_u32 s55, s53, 20480
  buffer_load_dwordx4 v164, s[12:15], s55 offen nt lds
  v_exp_f32 v8, v8
  v_mfma_f32_32x32x16_bf16 v[32:47], a[72:75], v[136:139], v[32:47]
  v_exp_f32 v9, v9
  v_add_f32 v233, v233, v6
  v_add_f32 v233, v233, v7
  v_cvt_pk_bf16_f32 v3, v6, v7
  v_mfma_f32_32x32x16_bf16 v[32:47], a[76:79], v[140:143], v[32:47]
  v_exp_f32 v10, v10
  v_exp_f32 v11, v11
  v_mfma_f32_32x32x16_bf16 v[32:47], a[80:83], v[144:147], v[32:47]
  v_mfma_f32_32x32x16_bf16 v[32:47], a[84:87], v[148:151], v[32:47]
  buffer_load_dwordx4 v164, s[12:15], s55 offen offset:1024 nt lds
  v_add_f32 v233, v233, v8
  v_mfma_f32_32x32x16_bf16 v[32:47], a[88:91], v[152:155], v[32:47]
  v_mfma_f32_32x32x16_bf16 v[32:47], a[92:95], v[156:159], v[32:47]
  v_add_f32 v233, v233, v9
  v_cvt_pk_bf16_f32 v8, v8, v9
  v_exp_f32 v12, v12
  v_exp_f32 v13, v13
  v_mfma_f32_32x32x16_bf16 v[48:63], a[96:99], v[128:131], 0
  ds_read_b128 v[128:131], v216 offset:8192
  v_add_f32 v233, v233, v10
  v_add_f32 v233, v233, v11
  v_cvt_pk_bf16_f32 v9, v10, v11
  v_exp_f32 v14, v14
  v_mfma_f32_32x32x16_bf16 v[48:63], a[100:103], v[132:135], v[48:63]
  buffer_load_dwordx4 v164, s[12:15], s55 offen offset:2048 nt lds
  ds_read_b128 v[132:135], v217 offset:8192
  v_exp_f32 v15, v15
  v_add_f32 v233, v233, v12
  v_add_f32 v233, v233, v13
  v_cvt_pk_bf16_f32 v10, v12, v13
  v_mfma_f32_32x32x16_bf16 v[48:63], a[104:107], v[136:139], v[48:63]
  ds_read_b128 v[136:139], v218 offset:8192
  v_exp_f32 v16, v16
  v_exp_f32 v17, v17
  v_add_f32 v233, v233, v14
  v_mfma_f32_32x32x16_bf16 v[48:63], a[108:111], v[140:143], v[48:63]
  ds_read_b128 v[140:143], v219 offset:8192
  v_add_f32 v233, v233, v15
  v_cvt_pk_bf16_f32 v11, v14, v15
  v_exp_f32 v18, v18
  v_mfma_f32_32x32x16_bf16 v[48:63], a[112:115], v[144:147], v[48:63]
  ds_read_b128 v[144:147], v220 offset:8192
  v_mfma_f32_32x32x16_bf16 v[48:63], a[116:119], v[148:151], v[48:63]
  buffer_load_dwordx4 v164, s[12:15], s55 offen offset:3072 nt lds
  ds_read_b128 v[148:151], v221 offset:8192
  v_exp_f32 v19, v19
  v_add_f32 v233, v233, v16
  v_add_f32 v233, v233, v17
  v_cvt_pk_bf16_f32 v16, v16, v17
  v_mfma_f32_32x32x16_bf16 v[48:63], a[120:123], v[152:155], v[48:63]
  ds_read_b128 v[152:155], v222 offset:8192
  v_exp_f32 v20, v20
  v_exp_f32 v21, v21
  v_add_f32 v233, v233, v18
  v_mfma_f32_32x32x16_bf16 v[48:63], a[124:127], v[156:159], v[48:63]
  ds_read_b128 v[156:159], v223 offset:8192
  v_add_f32 v233, v233, v19
  v_cvt_pk_bf16_f32 v17, v18, v19
  v_exp_f32 v22, v22
  v_exp_f32 v23, v23
  v_add_f32 v233, v233, v20
  v_add_f32 v233, v233, v21
  v_cvt_pk_bf16_f32 v18, v20, v21
  s_add_u32 m0, s54, 24576
  s_add_u32 s55, s53, 24576
  buffer_load_dwordx4 v164, s[12:15], s55 offen nt lds
  v_exp_f32 v24, v24
  v_exp_f32 v25, v25
  v_add_f32 v233, v233, v22
  v_add_f32 v233, v233, v23
  v_cvt_pk_bf16_f32 v19, v22, v23
  v_exp_f32 v26, v26
  v_exp_f32 v27, v27
  v_add_f32 v233, v233, v24
  v_add_f32 v233, v233, v25
  v_cvt_pk_bf16_f32 v24, v24, v25
  buffer_load_dwordx4 v164, s[12:15], s55 offen offset:1024 nt lds
  v_exp_f32 v28, v28
  v_exp_f32 v29, v29
  v_add_f32 v233, v233, v26
  v_add_f32 v233, v233, v27
  v_cvt_pk_bf16_f32 v25, v26, v27
  v_exp_f32 v30, v30
  v_exp_f32 v31, v31
  v_add_f32 v233, v233, v28
  v_add_f32 v233, v233, v29
  v_cvt_pk_bf16_f32 v26, v28, v29
  v_exp_f32 v32, v32
  buffer_load_dwordx4 v164, s[12:15], s55 offen offset:2048 nt lds
  v_exp_f32 v33, v33
  v_add_f32 v233, v233, v30
  v_add_f32 v233, v233, v31
  v_cvt_pk_bf16_f32 v27, v30, v31
  v_exp_f32 v34, v34
  v_exp_f32 v35, v35
  v_add_f32 v233, v233, v32
  v_add_f32 v233, v233, v33
  v_cvt_pk_bf16_f32 v32, v32, v33
  v_exp_f32 v36, v36
  buffer_load_dwordx4 v164, s[12:15], s55 offen offset:3072 nt lds
  v_exp_f32 v37, v37
  v_add_f32 v233, v233, v34
  v_add_f32 v233, v233, v35
  v_cvt_pk_bf16_f32 v33, v34, v35
  v_exp_f32 v38, v38
  v_exp_f32 v39, v39
  v_add_f32 v233, v233, v36
  v_add_f32 v233, v233, v37
  v_cvt_pk_bf16_f32 v34, v36, v37
  v_exp_f32 v40, v40
  v_exp_f32 v41, v41
  v_add_f32 v233, v233, v38
  v_add_f32 v233, v233, v39
  v_cvt_pk_bf16_f32 v35, v38, v39
  s_add_u32 m0, s54, 28672
  s_add_u32 s55, s53, 28672
  buffer_load_dwordx4 v164, s[12:15], s55 offen nt lds
  v_exp_f32 v42, v42
  v_exp_f32 v43, v43
  v_add_f32 v233, v233, v40
  v_add_f32 v233, v233, v41
  v_cvt_pk_bf16_f32 v40, v40, v41
  v_exp_f32 v44, v44
  v_exp_f32 v45, v45
  v_add_f32 v233, v233, v42
  v_add_f32 v233, v233, v43
  v_cvt_pk_bf16_f32 v41, v42, v43
  buffer_load_dwordx4 v164, s[12:15], s55 offen offset:1024 nt lds
  v_exp_f32 v46, v46
  v_exp_f32 v47, v47
  v_add_f32 v233, v233, v44
  v_add_f32 v233, v233, v45
  v_cvt_pk_bf16_f32 v42, v44, v45
  v_exp_f32 v48, v48
  v_exp_f32 v49, v49
  v_add_f32 v233, v233, v46
  v_add_f32 v233, v233, v47
  v_cvt_pk_bf16_f32 v43, v46, v47
  v_exp_f32 v50, v50
  v_exp_f32 v51, v51
  v_add_f32 v233, v233, v48
  buffer_load_dwordx4 v164, s[12:15], s55 offen offset:2048 nt lds
  v_add_f32 v233, v233, v49
  v_cvt_pk_bf16_f32 v48, v48, v49
  v_exp_f32 v52, v52
  v_exp_f32 v53, v53
  v_add_f32 v233, v233, v50
  v_add_f32 v233, v233, v51
  v_cvt_pk_bf16_f32 v49, v50, v51
  v_exp_f32 v54, v54
  v_exp_f32 v55, v55
  v_add_f32 v233, v233, v52
  v_add_f32 v233, v233, v53
  v_cvt_pk_bf16_f32 v50, v52, v53
  buffer_load_dwordx4 v164, s[12:15], s55 offen offset:3072 nt lds
  v_exp_f32 v56, v56
  v_exp_f32 v57, v57
  v_add_f32 v233, v233, v54
  v_add_f32 v233, v233, v55
  v_cvt_pk_bf16_f32 v51, v54, v55
  v_exp_f32 v58, v58
  v_exp_f32 v59, v59
  v_add_f32 v233, v233, v56
  v_add_f32 v233, v233, v57
  s_waitcnt vmcnt(16)
  s_barrier
  s_waitcnt lgkmcnt(7)
  v_mfma_f32_32x32x16_bf16 v[64:79], a[0:3], v[128:131], 0
  ds_read_b64_tr_b16 a[128:129], v168 offset:32768
  ds_read_b64_tr_b16 a[130:131], v168 offset:34816
  v_cvt_pk_bf16_f32 v56, v56, v57
  v_exp_f32 v60, v60
  v_exp_f32 v61, v61
  v_add_f32 v233, v233, v58
  s_waitcnt lgkmcnt(8)
  v_mfma_f32_32x32x16_bf16 v[64:79], a[4:7], v[132:135], v[64:79]
  v_add_f32 v233, v233, v59
  v_cvt_pk_bf16_f32 v57, v58, v59
  v_exp_f32 v62, v62
  v_exp_f32 v63, v63
  s_waitcnt lgkmcnt(7)
  v_mfma_f32_32x32x16_bf16 v[64:79], a[8:11], v[136:139], v[64:79]
  ds_read_b64_tr_b16 a[160:161], v169 offset:32768
  ds_read_b64_tr_b16 a[162:163], v169 offset:34816
  v_add_f32 v233, v233, v60
  v_add_f32 v233, v233, v61
  v_cvt_pk_bf16_f32 v58, v60, v61
  v_add_f32 v233, v233, v62
  v_add_f32 v233, v233, v63
  s_waitcnt lgkmcnt(8)
  v_mfma_f32_32x32x16_bf16 v[64:79], a[12:15], v[140:143], v[64:79]
  v_mov_b32 v235, v233
  v_cvt_pk_bf16_f32 v59, v62, v63
  s_nop 0
  v_permlane32_swap_b32 v235, v233
  v_add_f32 v233, v233, v235
  s_waitcnt lgkmcnt(7)
  v_mfma_f32_32x32x16_bf16 v[64:79], a[16:19], v[144:147], v[64:79]
  ds_read_b64_tr_b16 a[192:193], v170 offset:32768
  ds_read_b64_tr_b16 a[194:195], v170 offset:34816
  s_waitcnt lgkmcnt(8)
  v_mfma_f32_32x32x16_bf16 v[64:79], a[20:23], v[148:151], v[64:79]
  s_waitcnt lgkmcnt(7)
  v_mfma_f32_32x32x16_bf16 v[64:79], a[24:27], v[152:155], v[64:79]
  ds_read_b64_tr_b16 a[224:225], v171 offset:32768
  ds_read_b64_tr_b16 a[226:227], v171 offset:34816
  s_waitcnt lgkmcnt(8)
  v_mfma_f32_32x32x16_bf16 v[64:79], a[28:31], v[156:159], v[64:79]
  v_mfma_f32_32x32x16_bf16 v[80:95], a[32:35], v[128:131], 0
  ds_read_b64_tr_b16 a[132:133], v168 offset:36864
  ds_read_b64_tr_b16 a[134:135], v168 offset:38912
  v_mfma_f32_32x32x16_bf16 v[80:95], a[36:39], v[132:135], v[80:95]
  v_mfma_f32_32x32x16_bf16 v[80:95], a[40:43], v[136:139], v[80:95]
  ds_read_b64_tr_b16 a[164:165], v169 offset:36864
  ds_read_b64_tr_b16 a[166:167], v169 offset:38912
  s_nop 4
  v_exp_f32 v64, v64
  v_exp_f32 v65, v65
  v_mfma_f32_32x32x16_bf16 v[80:95], a[44:47], v[140:143], v[80:95]
  v_exp_f32 v66, v66
  v_exp_f32 v67, v67
  v_add_f32 v234, v64, v65
  v_mfma_f32_32x32x16_bf16 v[80:95], a[48:51], v[144:147], v[80:95]
  ds_read_b64_tr_b16 a[196:197], v170 offset:36864
  ds_read_b64_tr_b16 a[198:199], v170 offset:38912
  v_cvt_pk_bf16_f32 v64, v64, v65
  v_mfma_f32_32x32x16_bf16 v[80:95], a[52:55], v[148:151], v[80:95]
  v_exp_f32 v68, v68
  v_exp_f32 v69, v69
  v_add_f32 v234, v234, v66
  v_add_f32 v234, v234, v67
  v_mfma_f32_32x32x16_bf16 v[80:95], a[56:59], v[152:155], v[80:95]
  ds_read_b64_tr_b16 a[228:229], v171 offset:36864
  ds_read_b64_tr_b16 a[230:231], v171 offset:38912
  v_cvt_pk_bf16_f32 v65, v66, v67
  v_exp_f32 v70, v70
  v_exp_f32 v71, v71
  v_add_f32 v234, v234, v68
  v_mfma_f32_32x32x16_bf16 v[80:95], a[60:63], v[156:159], v[80:95]
  v_add_f32 v234, v234, v69
  v_mfma_f32_32x32x16_bf16 v[96:111], a[64:67], v[128:131], 0
  ds_read_b64_tr_b16 a[136:137], v168 offset:40960
  ds_read_b64_tr_b16 a[138:139], v168 offset:43008
  v_cvt_pk_bf16_f32 v66, v68, v69
  v_mfma_f32_32x32x16_bf16 v[96:111], a[68:71], v[132:135], v[96:111]
  v_exp_f32 v72, v72
  v_mfma_f32_32x32x16_bf16 v[96:111], a[72:75], v[136:139], v[96:111]
  ds_read_b64_tr_b16 a[168:169], v169 offset:40960
  ds_read_b64_tr_b16 a[170:171], v169 offset:43008
  v_exp_f32 v73, v73
  v_add_f32 v234, v234, v70
  v_add_f32 v234, v234, v71
  v_cvt_pk_bf16_f32 v67, v70, v71
  v_mfma_f32_32x32x16_bf16 v[96:111], a[76:79], v[140:143], v[96:111]
  v_exp_f32 v74, v74
  v_exp_f32 v75, v75
  v_mfma_f32_32x32x16_bf16 v[96:111], a[80:83], v[144:147], v[96:111]
  ds_read_b64_tr_b16 a[200:201], v170 offset:40960
  ds_read_b64_tr_b16 a[202:203], v170 offset:43008
  v_mfma_f32_32x32x16_bf16 v[96:111], a[84:87], v[148:151], v[96:111]
  v_add_f32 v234, v234, v72
  v_mfma_f32_32x32x16_bf16 v[96:111], a[88:91], v[152:155], v[96:111]
  ds_read_b64_tr_b16 a[232:233], v171 offset:40960
  ds_read_b64_tr_b16 a[234:235], v171 offset:43008
  v_mfma_f32_32x32x16_bf16 v[96:111], a[92:95], v[156:159], v[96:111]
  v_add_f32 v234, v234, v73
  v_cvt_pk_bf16_f32 v72, v72, v73
  v_exp_f32 v76, v76
  v_exp_f32 v77, v77
  v_mfma_f32_32x32x16_bf16 v[112:127], a[96:99], v[128:131], 0
  ds_read_b64_tr_b16 a[140:141], v168 offset:45056
  ds_read_b64_tr_b16 a[142:143], v168 offset:47104
  v_add_f32 v234, v234, v74
  v_add_f32 v234, v234, v75
  v_cvt_pk_bf16_f32 v73, v74, v75
  v_exp_f32 v78, v78
  v_mfma_f32_32x32x16_bf16 v[112:127], a[100:103], v[132:135], v[112:127]
  v_exp_f32 v79, v79
  v_add_f32 v234, v234, v76
  v_add_f32 v234, v234, v77
  v_cvt_pk_bf16_f32 v74, v76, v77
  v_mfma_f32_32x32x16_bf16 v[112:127], a[104:107], v[136:139], v[112:127]
  ds_read_b64_tr_b16 a[172:173], v169 offset:45056
  ds_read_b64_tr_b16 a[174:175], v169 offset:47104
  v_exp_f32 v80, v80
  v_exp_f32 v81, v81
  v_add_f32 v234, v234, v78
  v_mfma_f32_32x32x16_bf16 v[112:127], a[108:111], v[140:143], v[112:127]
  v_add_f32 v234, v234, v79
  v_cvt_pk_bf16_f32 v75, v78, v79
  v_exp_f32 v82, v82
  v_mfma_f32_32x32x16_bf16 v[112:127], a[112:115], v[144:147], v[112:127]
  ds_read_b64_tr_b16 a[204:205], v170 offset:45056
  ds_read_b64_tr_b16 a[206:207], v170 offset:47104
  v_mfma_f32_32x32x16_bf16 v[112:127], a[116:119], v[148:151], v[112:127]
  v_exp_f32 v83, v83
  v_add_f32 v234, v234, v80
  v_add_f32 v234, v234, v81
  v_cvt_pk_bf16_f32 v80, v80, v81
  v_mfma_f32_32x32x16_bf16 v[112:127], a[120:123], v[152:155], v[112:127]
  ds_read_b64_tr_b16 a[236:237], v171 offset:45056
  ds_read_b64_tr_b16 a[238:239], v171 offset:47104
  v_exp_f32 v84, v84
  v_exp_f32 v85, v85
  v_add_f32 v234, v234, v82
  v_mfma_f32_32x32x16_bf16 v[112:127], a[124:127], v[156:159], v[112:127]
  v_add_f32 v234, v234, v83
  v_cvt_pk_bf16_f32 v81, v82, v83
  v_exp_f32 v86, v86
  s_add_u32 m0, s24, 24576
  s_nop 0
  buffer_load_dwordx4 v231, s[4:7], s21 offen nt lds
  buffer_load_dwordx4 v232, s[4:7], s21 offen offset:1024 nt lds
  s_add_u32 s21, s21, 8192
  s_waitcnt vmcnt(2)
  s_barrier
  ds_read_b64_tr_b16 a[144:145], v168 offset:49152
  ds_read_b64_tr_b16 a[146:147], v168 offset:51200
  s_waitcnt lgkmcnt(8)
  ds_read_b64_tr_b16 a[176:177], v169 offset:49152
  ds_read_b64_tr_b16 a[178:179], v169 offset:51200
  ds_read_b64_tr_b16 a[208:209], v170 offset:49152
  ds_read_b64_tr_b16 a[210:211], v170 offset:51200
  ds_read_b64_tr_b16 a[240:241], v171 offset:49152
  ds_read_b64_tr_b16 a[242:243], v171 offset:51200
  s_waitcnt lgkmcnt(8)
  ds_read_b64_tr_b16 a[148:149], v168 offset:53248
  ds_read_b64_tr_b16 a[150:151], v168 offset:55296
  ds_read_b64_tr_b16 a[180:181], v169 offset:53248
  ds_read_b64_tr_b16 a[182:183], v169 offset:55296
  ds_read_b64_tr_b16 a[212:213], v170 offset:53248
  ds_read_b64_tr_b16 a[214:215], v170 offset:55296
  s_waitcnt lgkmcnt(8)
  ds_read_b64_tr_b16 a[244:245], v171 offset:53248
  ds_read_b64_tr_b16 a[246:247], v171 offset:55296
  ds_read_b64_tr_b16 a[152:153], v168 offset:57344
  ds_read_b64_tr_b16 a[154:155], v168 offset:59392
  ds_read_b64_tr_b16 a[184:185], v169 offset:57344
  ds_read_b64_tr_b16 a[186:187], v169 offset:59392
  s_waitcnt lgkmcnt(8)
  ds_read_b64_tr_b16 a[216:217], v170 offset:57344
  ds_read_b64_tr_b16 a[218:219], v170 offset:59392
  ds_read_b64_tr_b16 a[248:249], v171 offset:57344
  ds_read_b64_tr_b16 a[250:251], v171 offset:59392
  ds_read_b64_tr_b16 a[156:157], v168 offset:61440
  ds_read_b64_tr_b16 a[158:159], v168 offset:63488
  s_waitcnt lgkmcnt(8)
  ds_read_b64_tr_b16 a[188:189], v169 offset:61440
  ds_read_b64_tr_b16 a[190:191], v169 offset:63488
  ds_read_b64_tr_b16 a[220:221], v170 offset:61440
  ds_read_b64_tr_b16 a[222:223], v170 offset:63488
  ds_read_b64_tr_b16 a[252:253], v171 offset:61440
  ds_read_b64_tr_b16 a[254:255], v171 offset:63488
  s_waitcnt lgkmcnt(8)
  s_waitcnt lgkmcnt(0)
  s_barrier
  v_mfma_f32_32x32x16_bf16 v[192:207], a[128:131], v[0:3], 0
  ds_write_b128 v224, v[0:3] offset:0
  ds_write_b32 v228, v233 offset:0
  v_exp_f32 v87, v87
  v_add_f32 v234, v234, v84
  v_add_f32 v234, v234, v85
  v_cvt_pk_bf16_f32 v82, v84, v85
  v_mfma_f32_32x32x16_bf16 v[192:207], a[132:135], v[8:11], v[192:207]
  ds_write_b128 v224, v[8:11] offset:1024
  ds_write_b128 v224, v[64:67] offset:32768
  v_exp_f32 v88, v88
  v_exp_f32 v89, v89
  v_add_f32 v234, v234, v86
  v_mfma_f32_32x32x16_bf16 v[192:207], a[136:139], v[16:19], v[192:207]
  ds_write_b128 v224, v[16:19] offset:2048
  ds_write_b128 v224, v[72:75] offset:33792
  v_add_f32 v234, v234, v87
  v_cvt_pk_bf16_f32 v83, v86, v87
  v_exp_f32 v90, v90
  v_mfma_f32_32x32x16_bf16 v[192:207], a[140:143], v[24:27], v[192:207]
  ds_write_b128 v224, v[24:27] offset:3072
  v_mfma_f32_32x32x16_bf16 v[192:207], a[144:147], v[32:35], v[192:207]
  ds_write_b128 v224, v[32:35] offset:4096
  v_exp_f32 v91, v91
  v_add_f32 v234, v234, v88
  v_add_f32 v234, v234, v89
  v_cvt_pk_bf16_f32 v88, v88, v89
  v_mfma_f32_32x32x16_bf16 v[192:207], a[148:151], v[40:43], v[192:207]
  ds_write_b128 v224, v[40:43] offset:5120
  v_exp_f32 v92, v92
  v_exp_f32 v93, v93
  v_add_f32 v234, v234, v90
  v_mfma_f32_32x32x16_bf16 v[192:207], a[152:155], v[48:51], v[192:207]
  ds_write_b128 v224, v[48:51] offset:6144
  v_add_f32 v234, v234, v91
  v_cvt_pk_bf16_f32 v89, v90, v91
  v_exp_f32 v94, v94
  v_mfma_f32_32x32x16_bf16 v[192:207], a[156:159], v[56:59], v[192:207]
  ds_write_b128 v224, v[56:59] offset:7168
  v_exp_f32 v95, v95
  v_add_f32 v234, v234, v92
  v_add_f32 v234, v234, v93
  s_add_u32 m0, s24, 0
  s_nop 0
  buffer_load_dwordx4 v231, s[4:7], s21 offen nt lds
  buffer_load_dwordx4 v232, s[4:7], s21 offen offset:1024 nt lds
  s_add_u32 s21, s21, 8192
  s_add_u32 m0, s24, 8192
  s_nop 0
  buffer_load_dwordx4 v231, s[4:7], s21 offen nt lds
  buffer_load_dwordx4 v232, s[4:7], s21 offen offset:1024 nt lds
  s_add_u32 s21, s21, 8192
  s_waitcnt lgkmcnt(0)
  s_barrier
  ds_read_b128 v[160:163], v225 offset:0
  ds_read_b128 v[164:167], v225 offset:1024
  ds_read_b128 v[168:171], v225 offset:2048
  ds_read_b128 v[172:175], v225 offset:3072
  ds_read_b128 v[176:179], v225 offset:4096
  ds_read_b128 v[180:183], v225 offset:5120
  ds_read_b128 v[184:187], v225 offset:6144
  ds_read_b128 v[188:191], v225 offset:7168
  ds_read_b128 v[236:239], v229 offset:0
  ds_read_b128 v[128:131], v216 offset:16384
  ds_read_b128 v[132:135], v217 offset:16384
  ds_read_b128 v[136:139], v218 offset:16384
  ds_read_b128 v[140:143], v219 offset:16384
  ds_read_b128 v[144:147], v220 offset:16384
  ds_read_b128 v[148:151], v221 offset:16384
  ds_read_b128 v[152:155], v222 offset:16384
  ds_read_b128 v[156:159], v223 offset:16384
  s_waitcnt lgkmcnt(8)
  v_add_f32 v242, v236, v237
  v_add_f32 v238, v238, v239
  v_add_f32 v242, v242, v238
  ds_write_b128 v224, v[80:83] offset:34816
  v_mfma_f32_32x32x16_bf16 v[192:207], a[160:163], v[160:163], v[192:207]
  ds_read_b128 v[160:163], v226 offset:0
  v_cvt_pk_bf16_f32 v90, v92, v93
  v_rcp_f32 v240, v242
  v_exp_f32 v96, v96
  v_mfma_f32_32x32x16_bf16 v[192:207], a[164:167], v[164:167], v[192:207]
  ds_read_b128 v[164:167], v226 offset:1024
  v_exp_f32 v97, v97
  v_add_f32 v234, v234, v94
  v_add_f32 v234, v234, v95
  v_cvt_pk_bf16_f32 v91, v94, v95
  v_mfma_f32_32x32x16_bf16 v[192:207], a[168:171], v[168:171], v[192:207]
  ds_read_b128 v[168:171], v226 offset:2048
  ds_write_b128 v224, v[88:91] offset:35840
  v_mfma_f32_32x32x16_bf16 v[192:207], a[172:175], v[172:175], v[192:207]
  ds_read_b128 v[172:175], v226 offset:3072
  v_exp_f32 v98, v98
  v_exp_f32 v99, v99
  v_mfma_f32_32x32x16_bf16 v[192:207], a[176:179], v[176:179], v[192:207]
  ds_read_b128 v[176:179], v226 offset:4096
  v_add_f32 v234, v234, v96
  v_add_f32 v234, v234, v97
  v_cvt_pk_bf16_f32 v96, v96, v97
  v_exp_f32 v100, v100
  v_mfma_f32_32x32x16_bf16 v[192:207], a[180:183], v[180:183], v[192:207]
  ds_read_b128 v[180:183], v226 offset:5120
  v_exp_f32 v101, v101
  v_add_f32 v234, v234, v98
  v_add_f32 v234, v234, v99
  v_cvt_pk_bf16_f32 v97, v98, v99
  v_mfma_f32_32x32x16_bf16 v[192:207], a[184:187], v[184:187], v[192:207]
  ds_read_b128 v[184:187], v226 offset:6144
  v_exp_f32 v102, v102
  v_exp_f32 v103, v103
  v_add_f32 v234, v234, v100
  v_mfma_f32_32x32x16_bf16 v[192:207], a[188:191], v[188:191], v[192:207]
  ds_read_b128 v[188:191], v226 offset:7168
  v_add_f32 v234, v234, v101
  v_cvt_pk_bf16_f32 v98, v100, v101
  v_exp_f32 v104, v104
  s_waitcnt lgkmcnt(4)
  v_mfma_f32_32x32x16_bf16 v[192:207], a[192:195], v[160:163], v[192:207]
  ds_read_b128 v[160:163], v227 offset:0
  v_exp_f32 v105, v105
  v_add_f32 v234, v234, v102
  v_add_f32 v234, v234, v103
  v_cvt_pk_bf16_f32 v99, v102, v103
  v_mfma_f32_32x32x16_bf16 v[192:207], a[196:199], v[164:167], v[192:207]
  ds_read_b128 v[164:167], v227 offset:1024
  ds_write_b128 v224, v[96:99] offset:36864
  v_mfma_f32_32x32x16_bf16 v[192:207], a[200:203], v[168:171], v[192:207]
  ds_read_b128 v[168:171], v227 offset:2048
  v_exp_f32 v106, v106
  v_exp_f32 v107, v107
  v_add_f32 v234, v234, v104
  v_mfma_f32_32x32x16_bf16 v[192:207], a[204:207], v[172:175], v[192:207]
  ds_read_b128 v[172:175], v227 offset:3072
  v_add_f32 v234, v234, v105
  v_cvt_pk_bf16_f32 v104, v104, v105
  v_exp_f32 v108, v108
  s_waitcnt lgkmcnt(5)
  v_mfma_f32_32x32x16_bf16 v[192:207], a[208:211], v[176:179], v[192:207]
  ds_read_b128 v[176:179], v227 offset:4096
  v_exp_f32 v109, v109
  v_add_f32 v234, v234, v106
  v_add_f32 v234, v234, v107
  v_cvt_pk_bf16_f32 v105, v106, v107
  v_mfma_f32_32x32x16_bf16 v[192:207], a[212:215], v[180:183], v[192:207]
  ds_read_b128 v[180:183], v227 offset:5120
  v_exp_f32 v110, v110
  v_exp_f32 v111, v111
  v_add_f32 v234, v234, v108
  v_mfma_f32_32x32x16_bf16 v[192:207], a[216:219], v[184:187], v[192:207]
  ds_read_b128 v[184:187], v227 offset:6144
  v_add_f32 v234, v234, v109
  v_cvt_pk_bf16_f32 v106, v108, v109
  v_exp_f32 v112, v112
  v_maximum3_f32 v243, v243, v242, v240
  v_mfma_f32_32x32x16_bf16 v[192:207], a[220:223], v[188:191], v[192:207]
  ds_read_b128 v[188:191], v227 offset:7168
  v_exp_f32 v113, v113
  v_add_f32 v234, v234, v110
  v_add_f32 v234, v234, v111
  s_waitcnt lgkmcnt(4)
  v_mfma_f32_32x32x16_bf16 v[192:207], a[224:227], v[160:163], v[192:207]
  v_cvt_pk_bf16_f32 v107, v110, v111
  v_exp_f32 v114, v114
  v_exp_f32 v115, v115
  v_add_f32 v234, v234, v112
  v_mfma_f32_32x32x16_bf16 v[192:207], a[228:231], v[164:167], v[192:207]
  ds_write_b128 v224, v[104:107] offset:37888
  v_add_f32 v234, v234, v113
  v_mfma_f32_32x32x16_bf16 v[192:207], a[232:235], v[168:171], v[192:207]
  v_cvt_pk_bf16_f32 v112, v112, v113
  v_exp_f32 v116, v116
  v_exp_f32 v117, v117
  v_add_f32 v234, v234, v114
  v_mfma_f32_32x32x16_bf16 v[192:207], a[236:239], v[172:175], v[192:207]
  v_add_f32 v234, v234, v115
  v_cvt_pk_bf16_f32 v113, v114, v115
  v_exp_f32 v118, v118
  s_waitcnt lgkmcnt(1)
  v_mfma_f32_32x32x16_bf16 v[192:207], a[240:243], v[176:179], v[192:207]
  v_exp_f32 v119, v119
  v_add_f32 v234, v234, v116
  v_add_f32 v234, v234, v117
  v_cvt_pk_bf16_f32 v114, v116, v117
  v_mfma_f32_32x32x16_bf16 v[192:207], a[244:247], v[180:183], v[192:207]
  v_exp_f32 v120, v120
  v_exp_f32 v121, v121
  v_add_f32 v234, v234, v118
  v_add_f32 v234, v234, v119
  v_mfma_f32_32x32x16_bf16 v[192:207], a[248:251], v[184:187], v[192:207]
  v_cvt_pk_bf16_f32 v115, v118, v119
  v_exp_f32 v122, v122
  v_exp_f32 v123, v123
  v_add_f32 v234, v234, v120
  v_mfma_f32_32x32x16_bf16 v[192:207], a[252:255], v[188:191], v[192:207]
  ds_write_b128 v224, v[112:115] offset:38912
  v_add_f32 v234, v234, v121
  s_waitcnt vmcnt(4)
  s_waitcnt lgkmcnt(0)
  s_mov_b32 s23, 7
L_loop:
  v_mfma_f32_32x32x16_bf16 v[0:15], a[0:3], v[128:131], 0
  v_cvt_pk_bf16_f32 v120, v120, v121
  v_exp_f32 v124, v124
  v_exp_f32 v125, v125
  v_add_f32 v234, v234, v122
  v_mfma_f32_32x32x16_bf16 v[0:15], a[4:7], v[132:135], v[0:15]
  v_add_f32 v234, v234, v123
  v_cvt_pk_bf16_f32 v121, v122, v123
  v_exp_f32 v126, v126
  v_exp_f32 v127, v127
  v_mfma_f32_32x32x16_bf16 v[0:15], a[8:11], v[136:139], v[0:15]
  v_add_f32 v234, v234, v124
  v_add_f32 v234, v234, v125
  v_cvt_pk_bf16_f32 v122, v124, v125
  v_add_f32 v234, v234, v126
  v_add_f32 v234, v234, v127
  v_mfma_f32_32x32x16_bf16 v[0:15], a[12:15], v[140:143], v[0:15]
  v_mov_b32 v235, v234
  v_cvt_pk_bf16_f32 v123, v126, v127
  s_add_u32 m0, s24, 16384
  v_permlane32_swap_b32 v235, v234
  v_add_f32 v234, v234, v235
  v_mfma_f32_32x32x16_bf16 v[0:15], a[16:19], v[144:147], v[0:15]
  ds_write_b128 v224, v[120:123] offset:39936
  v_mul_f32 v192, v192, v240
  v_mfma_f32_32x32x16_bf16 v[0:15], a[20:23], v[148:151], v[0:15]
  ds_write_b32 v228, v234 offset:512
  v_mul_f32 v193, v193, v240
  v_cvt_pk_bf16_f32 v208, v192, v193
  v_mul_f32 v194, v194, v240
  v_mul_f32 v195, v195, v240
  v_mfma_f32_32x32x16_bf16 v[0:15], a[24:27], v[152:155], v[0:15]
  v_cvt_pk_bf16_f32 v209, v194, v195
  v_mul_f32 v196, v196, v240
  v_mul_f32 v197, v197, v240
  v_cvt_pk_bf16_f32 v210, v196, v197
  v_mul_f32 v198, v198, v240
  v_mfma_f32_32x32x16_bf16 v[0:15], a[28:31], v[156:159], v[0:15]
  v_mul_f32 v199, v199, v240
  v_cvt_pk_bf16_f32 v211, v198, v199
  v_mul_f32 v200, v200, v240
  v_mul_f32 v201, v201, v240
  v_cvt_pk_bf16_f32 v212, v200, v201
  v_mfma_f32_32x32x16_bf16 v[16:31], a[32:35], v[128:131], 0
  ds_write_b128 v244, v[208:211] offset:0
  v_mul_f32 v202, v202, v240
  v_mfma_f32_32x32x16_bf16 v[16:31], a[36:39], v[132:135], v[16:31]
  v_mul_f32 v203, v203, v240
  v_cvt_pk_bf16_f32 v213, v202, v203
  v_mul_f32 v204, v204, v240
  v_mul_f32 v205, v205, v240
  v_cvt_pk_bf16_f32 v214, v204, v205
  v_mfma_f32_32x32x16_bf16 v[16:31], a[40:43], v[136:139], v[16:31]
  v_mul_f32 v206, v206, v240
  v_exp_f32 v0, v0
  v_mul_f32 v207, v207, v240
  v_exp_f32 v1, v1
  v_mfma_f32_32x32x16_bf16 v[16:31], a[44:47], v[140:143], v[16:31]
  v_cvt_pk_bf16_f32 v215, v206, v207
  v_exp_f32 v2, v2
  v_exp_f32 v3, v3
  v_add_f32 v233, v0, v1
  v_mfma_f32_32x32x16_bf16 v[16:31], a[48:51], v[144:147], v[16:31]
  ds_write_b128 v245, v[212:215] offset:0
  v_cvt_pk_bf16_f32 v0, v0, v1
  v_mfma_f32_32x32x16_bf16 v[16:31], a[52:55], v[148:151], v[16:31]
  v_exp_f32 v4, v4
  v_exp_f32 v5, v5
  v_add_f32 v233, v233, v2
  v_add_f32 v233, v233, v3
  v_mfma_f32_32x32x16_bf16 v[16:31], a[56:59], v[152:155], v[16:31]
  v_cvt_pk_bf16_f32 v1, v2, v3
  v_exp_f32 v6, v6
  v_exp_f32 v7, v7
  v_add_f32 v233, v233, v4
  v_mfma_f32_32x32x16_bf16 v[16:31], a[60:63], v[156:159], v[16:31]
  s_waitcnt vmcnt(6) lgkmcnt(0)
  s_barrier
  v_add_f32 v233, v233, v5
  v_mfma_f32_32x32x16_bf16 v[32:47], a[64:67], v[128:131], 0
  ds_read_b128 v[236:239], v229 offset:512
  buffer_load_dwordx4 v231, s[4:7], s21 offen nt lds
  v_cvt_pk_bf16_f32 v2, v4, v5
  v_mfma_f32_32x32x16_bf16 v[32:47], a[68:71], v[132:135], v[32:47]
  ds_read_b128 v[208:211], v246 offset:0
  buffer_load_dwordx4 v232, s[4:7], s21 offen offset:1024 nt lds
  v_exp_f32 v8, v8
  v_mfma_f32_32x32x16_bf16 v[32:47], a[72:75], v[136:139], v[32:47]
  ds_read_b128 v[212:215], v247 offset:0
  v_exp_f32 v9, v9
  v_add_f32 v233, v233, v6
  v_add_f32 v233, v233, v7
  v_cvt_pk_bf16_f32 v3, v6, v7
  v_mfma_f32_32x32x16_bf16 v[32:47], a[76:79], v[140:143], v[32:47]
  v_exp_f32 v10, v10
  v_exp_f32 v11, v11
  v_mfma_f32_32x32x16_bf16 v[32:47], a[80:83], v[144:147], v[32:47]
  s_waitcnt lgkmcnt(1)
  buffer_store_dwordx4 v[208:211], v248, s[16:19], s22 offen sc1
  v_mfma_f32_32x32x16_bf16 v[32:47], a[84:87], v[148:151], v[32:47]
  ds_write_b128 v224, v[0:3] offset:0
  v_add_f32 v233, v233, v8
  v_mfma_f32_32x32x16_bf16 v[32:47], a[88:91], v[152:155], v[32:47]
  s_waitcnt lgkmcnt(1)
  buffer_store_dwordx4 v[212:215], v248, s[16:19], s22 offen offset:1024 sc1
  v_mfma_f32_32x32x16_bf16 v[32:47], a[92:95], v[156:159], v[32:47]
  v_add_f32 v233, v233, v9
  v_cvt_pk_bf16_f32 v8, v8, v9
  v_exp_f32 v12, v12
  v_exp_f32 v13, v13
  v_mfma_f32_32x32x16_bf16 v[48:63], a[96:99], v[128:131], 0
  ds_read_b128 v[128:131], v216 offset:24576
  v_add_f32 v233, v233, v10
  v_add_f32 v233, v233, v11
  v_cvt_pk_bf16_f32 v9, v10, v11
  v_exp_f32 v14, v14
  v_mfma_f32_32x32x16_bf16 v[48:63], a[100:103], v[132:135], v[48:63]
  ds_read_b128 v[132:135], v217 offset:24576
  v_exp_f32 v15, v15
  v_add_f32 v233, v233, v12
  v_add_f32 v233, v233, v13
  v_cvt_pk_bf16_f32 v10, v12, v13
  v_mfma_f32_32x32x16_bf16 v[48:63], a[104:107], v[136:139], v[48:63]
  ds_read_b128 v[136:139], v218 offset:24576
  v_exp_f32 v16, v16
  v_exp_f32 v17, v17
  v_add_f32 v233, v233, v14
  v_mfma_f32_32x32x16_bf16 v[48:63], a[108:111], v[140:143], v[48:63]
  ds_read_b128 v[140:143], v219 offset:24576
  v_add_f32 v233, v233, v15
  v_cvt_pk_bf16_f32 v11, v14, v15
  v_exp_f32 v18, v18
  v_add_f32 v242, v236, v237
  v_mfma_f32_32x32x16_bf16 v[48:63], a[112:115], v[144:147], v[48:63]
  ds_read_b128 v[144:147], v220 offset:24576
  ds_write_b128 v224, v[8:11] offset:1024
  v_mfma_f32_32x32x16_bf16 v[48:63], a[116:119], v[148:151], v[48:63]
  ds_read_b128 v[148:151], v221 offset:24576
  v_exp_f32 v19, v19
  v_add_f32 v233, v233, v16
  v_add_f32 v233, v233, v17
  v_cvt_pk_bf16_f32 v16, v16, v17
  v_mfma_f32_32x32x16_bf16 v[48:63], a[120:123], v[152:155], v[48:63]
  ds_read_b128 v[152:155], v222 offset:24576
  v_exp_f32 v20, v20
  v_exp_f32 v21, v21
  v_add_f32 v233, v233, v18
  v_mfma_f32_32x32x16_bf16 v[48:63], a[124:127], v[156:159], v[48:63]
  ds_read_b128 v[156:159], v223 offset:24576
  v_add_f32 v233, v233, v19
  v_cvt_pk_bf16_f32 v17, v18, v19
  v_exp_f32 v22, v22
  v_add_f32 v238, v238, v239
  v_mfma_f32_32x32x16_bf16 v[192:207], a[128:131], v[64:67], 0
  ds_read_b128 v[160:163], v225 offset:32768
  v_exp_f32 v23, v23
  v_add_f32 v233, v233, v20
  v_add_f32 v233, v233, v21
  v_cvt_pk_bf16_f32 v18, v20, v21
  v_mfma_f32_32x32x16_bf16 v[192:207], a[132:135], v[72:75], v[192:207]
  ds_read_b128 v[164:167], v225 offset:33792
  v_exp_f32 v24, v24
  v_exp_f32 v25, v25
  v_add_f32 v233, v233, v22
  v_mfma_f32_32x32x16_bf16 v[192:207], a[136:139], v[80:83], v[192:207]
  ds_read_b128 v[168:171], v225 offset:34816
  v_add_f32 v233, v233, v23
  v_cvt_pk_bf16_f32 v19, v22, v23
  v_exp_f32 v26, v26
  v_add_f32 v242, v242, v238
  v_mfma_f32_32x32x16_bf16 v[192:207], a[140:143], v[88:91], v[192:207]
  ds_read_b128 v[172:175], v225 offset:35840
  ds_write_b128 v224, v[16:19] offset:2048
  v_mfma_f32_32x32x16_bf16 v[192:207], a[144:147], v[96:99], v[192:207]
  ds_read_b128 v[176:179], v225 offset:36864
  v_exp_f32 v27, v27
  v_add_f32 v233, v233, v24
  v_add_f32 v233, v233, v25
  v_cvt_pk_bf16_f32 v24, v24, v25
  v_mfma_f32_32x32x16_bf16 v[192:207], a[148:151], v[104:107], v[192:207]
  ds_read_b128 v[180:183], v225 offset:37888
  v_exp_f32 v28, v28
  v_exp_f32 v29, v29
  v_add_f32 v233, v233, v26
  v_mfma_f32_32x32x16_bf16 v[192:207], a[152:155], v[112:115], v[192:207]
  ds_read_b128 v[184:187], v225 offset:38912
  v_add_f32 v233, v233, v27
  v_cvt_pk_bf16_f32 v25, v26, v27
  v_exp_f32 v30, v30
  s_add_u32 s21, s21, 8192
  v_mfma_f32_32x32x16_bf16 v[192:207], a[156:159], v[120:123], v[192:207]
  ds_read_b128 v[188:191], v225 offset:39936
  v_exp_f32 v31, v31
  v_add_f32 v233, v233, v28
  v_add_f32 v233, v233, v29
  s_waitcnt lgkmcnt(5)
  v_mfma_f32_32x32x16_bf16 v[192:207], a[160:163], v[160:163], v[192:207]
  ds_read_b128 v[160:163], v226 offset:32768
  v_cvt_pk_bf16_f32 v26, v28, v29
  v_rcp_f32 v241, v242
  v_exp_f32 v32, v32
  v_mfma_f32_32x32x16_bf16 v[192:207], a[164:167], v[164:167], v[192:207]
  ds_read_b128 v[164:167], v226 offset:33792
  v_exp_f32 v33, v33
  v_add_f32 v233, v233, v30
  v_add_f32 v233, v233, v31
  v_cvt_pk_bf16_f32 v27, v30, v31
  v_mfma_f32_32x32x16_bf16 v[192:207], a[168:171], v[168:171], v[192:207]
  ds_read_b128 v[168:171], v226 offset:34816
  ds_write_b128 v224, v[24:27] offset:3072
  v_mfma_f32_32x32x16_bf16 v[192:207], a[172:175], v[172:175], v[192:207]
  ds_read_b128 v[172:175], v226 offset:35840
  v_exp_f32 v34, v34
  v_exp_f32 v35, v35
  s_waitcnt lgkmcnt(5)
  v_mfma_f32_32x32x16_bf16 v[192:207], a[176:179], v[176:179], v[192:207]
  ds_read_b128 v[176:179], v226 offset:36864
  v_add_f32 v233, v233, v32
  v_add_f32 v233, v233, v33
  v_cvt_pk_bf16_f32 v32, v32, v33
  v_exp_f32 v36, v36
  v_mfma_f32_32x32x16_bf16 v[192:207], a[180:183], v[180:183], v[192:207]
  ds_read_b128 v[180:183], v226 offset:37888
  v_exp_f32 v37, v37
  v_add_f32 v233, v233, v34
  v_add_f32 v233, v233, v35
  v_cvt_pk_bf16_f32 v33, v34, v35
  v_mfma_f32_32x32x16_bf16 v[192:207], a[184:187], v[184:187], v[192:207]
  ds_read_b128 v[184:187], v226 offset:38912
  v_exp_f32 v38, v38
  v_exp_f32 v39, v39
  v_add_f32 v233, v233, v36
  v_mfma_f32_32x32x16_bf16 v[192:207], a[188:191], v[188:191], v[192:207]
  ds_read_b128 v[188:191], v226 offset:39936
  v_add_f32 v233, v233, v37
  v_cvt_pk_bf16_f32 v34, v36, v37
  v_exp_f32 v40, v40
  s_waitcnt lgkmcnt(4)
  v_mfma_f32_32x32x16_bf16 v[192:207], a[192:195], v[160:163], v[192:207]
  ds_read_b128 v[160:163], v227 offset:32768
  v_exp_f32 v41, v41
  v_add_f32 v233, v233, v38
  v_add_f32 v233, v233, v39
  v_cvt_pk_bf16_f32 v35, v38, v39
  v_mfma_f32_32x32x16_bf16 v[192:207], a[196:199], v[164:167], v[192:207]
  ds_read_b128 v[164:167], v227 offset:33792
  ds_write_b128 v224, v[32:35] offset:4096
  v_mfma_f32_32x32x16_bf16 v[192:207], a[200:203], v[168:171], v[192:207]
  ds_read_b128 v[168:171], v227 offset:34816
  v_exp_f32 v42, v42
  v_exp_f32 v43, v43
  v_add_f32 v233, v233, v40
  v_mfma_f32_32x32x16_bf16 v[192:207], a[204:207], v[172:175], v[192:207]
  ds_read_b128 v[172:175], v227 offset:35840
  v_add_f32 v233, v233, v41
  v_cvt_pk_bf16_f32 v40, v40, v41
  v_exp_f32 v44, v44
  s_waitcnt lgkmcnt(5)
  v_mfma_f32_32x32x16_bf16 v[192:207], a[208:211], v[176:179], v[192:207]
  ds_read_b128 v[176:179], v227 offset:36864
  v_exp_f32 v45, v45
  v_add_f32 v233, v233, v42
  v_add_f32 v233, v233, v43
  v_cvt_pk_bf16_f32 v41, v42, v43
  v_mfma_f32_32x32x16_bf16 v[192:207], a[212:215], v[180:183], v[192:207]
  ds_read_b128 v[180:183], v227 offset:37888
  v_exp_f32 v46, v46
  v_exp_f32 v47, v47
  v_add_f32 v233, v233, v44
  v_mfma_f32_32x32x16_bf16 v[192:207], a[216:219], v[184:187], v[192:207]
  ds_read_b128 v[184:187], v227 offset:38912
  v_add_f32 v233, v233, v45
  v_cvt_pk_bf16_f32 v42, v44, v45
  v_exp_f32 v48, v48
  v_maximum3_f32 v243, v243, v242, v241
  v_mfma_f32_32x32x16_bf16 v[192:207], a[220:223], v[188:191], v[192:207]
  ds_read_b128 v[188:191], v227 offset:39936
  v_exp_f32 v49, v49
  v_add_f32 v233, v233, v46
  v_add_f32 v233, v233, v47
  s_waitcnt lgkmcnt(4)
  v_mfma_f32_32x32x16_bf16 v[192:207], a[224:227], v[160:163], v[192:207]
  v_cvt_pk_bf16_f32 v43, v46, v47
  v_exp_f32 v50, v50
  v_exp_f32 v51, v51
  v_add_f32 v233, v233, v48
  v_mfma_f32_32x32x16_bf16 v[192:207], a[228:231], v[164:167], v[192:207]
  ds_write_b128 v224, v[40:43] offset:5120
  v_add_f32 v233, v233, v49
  v_mfma_f32_32x32x16_bf16 v[192:207], a[232:235], v[168:171], v[192:207]
  v_cvt_pk_bf16_f32 v48, v48, v49
  v_exp_f32 v52, v52
  v_exp_f32 v53, v53
  v_add_f32 v233, v233, v50
  v_mfma_f32_32x32x16_bf16 v[192:207], a[236:239], v[172:175], v[192:207]
  v_add_f32 v233, v233, v51
  v_cvt_pk_bf16_f32 v49, v50, v51
  v_exp_f32 v54, v54
  s_add_u32 s22, s22, 8192
  s_waitcnt lgkmcnt(1)
  v_mfma_f32_32x32x16_bf16 v[192:207], a[240:243], v[176:179], v[192:207]
  v_exp_f32 v55, v55
  v_add_f32 v233, v233, v52
  v_add_f32 v233, v233, v53
  v_cvt_pk_bf16_f32 v50, v52, v53
  v_mfma_f32_32x32x16_bf16 v[192:207], a[244:247], v[180:183], v[192:207]
  v_exp_f32 v56, v56
  v_exp_f32 v57, v57
  v_add_f32 v233, v233, v54
  v_add_f32 v233, v233, v55
  v_mfma_f32_32x32x16_bf16 v[192:207], a[248:251], v[184:187], v[192:207]
  v_cvt_pk_bf16_f32 v51, v54, v55
  v_exp_f32 v58, v58
  v_exp_f32 v59, v59
  v_add_f32 v233, v233, v56
  v_mfma_f32_32x32x16_bf16 v[192:207], a[252:255], v[188:191], v[192:207]
  ds_write_b128 v224, v[48:51] offset:6144
  v_add_f32 v233, v233, v57
  v_mfma_f32_32x32x16_bf16 v[64:79], a[0:3], v[128:131], 0
  v_cvt_pk_bf16_f32 v56, v56, v57
  v_exp_f32 v60, v60
  v_exp_f32 v61, v61
  v_add_f32 v233, v233, v58
  v_mfma_f32_32x32x16_bf16 v[64:79], a[4:7], v[132:135], v[64:79]
  v_add_f32 v233, v233, v59
  v_cvt_pk_bf16_f32 v57, v58, v59
  v_exp_f32 v62, v62
  v_exp_f32 v63, v63
  v_mfma_f32_32x32x16_bf16 v[64:79], a[8:11], v[136:139], v[64:79]
  v_add_f32 v233, v233, v60
  v_add_f32 v233, v233, v61
  v_cvt_pk_bf16_f32 v58, v60, v61
  v_add_f32 v233, v233, v62
  v_add_f32 v233, v233, v63
  v_mfma_f32_32x32x16_bf16 v[64:79], a[12:15], v[140:143], v[64:79]
  v_mov_b32 v235, v233
  v_cvt_pk_bf16_f32 v59, v62, v63
  s_add_u32 m0, s24, 24576
  v_permlane32_swap_b32 v235, v233
  v_add_f32 v233, v233, v235
  v_mfma_f32_32x32x16_bf16 v[64:79], a[16:19], v[144:147], v[64:79]
  ds_write_b128 v224, v[56:59] offset:7168
  v_mul_f32 v192, v192, v241
  v_mfma_f32_32x32x16_bf16 v[64:79], a[20:23], v[148:151], v[64:79]
  ds_write_b32 v228, v233 offset:0
  v_mul_f32 v193, v193, v241
  v_cvt_pk_bf16_f32 v208, v192, v193
  v_mul_f32 v194, v194, v241
  v_mul_f32 v195, v195, v241
  v_mfma_f32_32x32x16_bf16 v[64:79], a[24:27], v[152:155], v[64:79]
  v_cvt_pk_bf16_f32 v209, v194, v195
  v_mul_f32 v196, v196, v241
  v_mul_f32 v197, v197, v241
  v_cvt_pk_bf16_f32 v210, v196, v197
  v_mul_f32 v198, v198, v241
  v_mfma_f32_32x32x16_bf16 v[64:79], a[28:31], v[156:159], v[64:79]
  v_mul_f32 v199, v199, v241
  v_cvt_pk_bf16_f32 v211, v198, v199
  v_mul_f32 v200, v200, v241
  v_mul_f32 v201, v201, v241
  v_cvt_pk_bf16_f32 v212, v200, v201
  v_mfma_f32_32x32x16_bf16 v[80:95], a[32:35], v[128:131], 0
  ds_write_b128 v244, v[208:211] offset:8192
  v_mul_f32 v202, v202, v241
  v_mfma_f32_32x32x16_bf16 v[80:95], a[36:39], v[132:135], v[80:95]
  v_mul_f32 v203, v203, v241
  v_cvt_pk_bf16_f32 v213, v202, v203
  v_mul_f32 v204, v204, v241
  v_mul_f32 v205, v205, v241
  v_cvt_pk_bf16_f32 v214, v204, v205
  v_mfma_f32_32x32x16_bf16 v[80:95], a[40:43], v[136:139], v[80:95]
  v_mul_f32 v206, v206, v241
  v_exp_f32 v64, v64
  v_mul_f32 v207, v207, v241
  v_exp_f32 v65, v65
  v_mfma_f32_32x32x16_bf16 v[80:95], a[44:47], v[140:143], v[80:95]
  v_cvt_pk_bf16_f32 v215, v206, v207
  v_exp_f32 v66, v66
  v_exp_f32 v67, v67
  v_add_f32 v234, v64, v65
  v_mfma_f32_32x32x16_bf16 v[80:95], a[48:51], v[144:147], v[80:95]
  ds_write_b128 v245, v[212:215] offset:8192
  v_cvt_pk_bf16_f32 v64, v64, v65
  v_mfma_f32_32x32x16_bf16 v[80:95], a[52:55], v[148:151], v[80:95]
  v_exp_f32 v68, v68
  v_exp_f32 v69, v69
  v_add_f32 v234, v234, v66
  v_add_f32 v234, v234, v67
  v_mfma_f32_32x32x16_bf16 v[80:95], a[56:59], v[152:155], v[80:95]
  v_cvt_pk_bf16_f32 v65, v66, v67
  v_exp_f32 v70, v70
  v_exp_f32 v71, v71
  v_add_f32 v234, v234, v68
  v_mfma_f32_32x32x16_bf16 v[80:95], a[60:63], v[156:159], v[80:95]
  s_waitcnt vmcnt(6) lgkmcnt(0)
  s_barrier
  v_add_f32 v234, v234, v69
  v_mfma_f32_32x32x16_bf16 v[96:111], a[64:67], v[128:131], 0
  ds_read_b128 v[236:239], v229 offset:0
  buffer_load_dwordx4 v231, s[4:7], s21 offen nt lds
  v_cvt_pk_bf16_f32 v66, v68, v69
  v_mfma_f32_32x32x16_bf16 v[96:111], a[68:71], v[132:135], v[96:111]
  ds_read_b128 v[208:211], v246 offset:8192
  buffer_load_dwordx4 v232, s[4:7], s21 offen offset:1024 nt lds
  v_exp_f32 v72, v72
  v_mfma_f32_32x32x16_bf16 v[96:111], a[72:75], v[136:139], v[96:111]
  ds_read_b128 v[212:215], v247 offset:8192
  v_exp_f32 v73, v73
  v_add_f32 v234, v234, v70
  v_add_f32 v234, v234, v71
  v_cvt_pk_bf16_f32 v67, v70, v71
  v_mfma_f32_32x32x16_bf16 v[96:111], a[76:79], v[140:143], v[96:111]
  v_exp_f32 v74, v74
  v_exp_f32 v75, v75
  v_mfma_f32_32x32x16_bf16 v[96:111], a[80:83], v[144:147], v[96:111]
  s_waitcnt lgkmcnt(1)
  buffer_store_dwordx4 v[208:211], v248, s[16:19], s22 offen sc1
  v_mfma_f32_32x32x16_bf16 v[96:111], a[84:87], v[148:151], v[96:111]
  ds_write_b128 v224, v[64:67] offset:32768
  v_add_f32 v234, v234, v72
  v_mfma_f32_32x32x16_bf16 v[96:111], a[88:91], v[152:155], v[96:111]
  s_waitcnt lgkmcnt(1)
  buffer_store_dwordx4 v[212:215], v248, s[16:19], s22 offen offset:1024 sc1
  v_mfma_f32_32x32x16_bf16 v[96:111], a[92:95], v[156:159], v[96:111]
  v_add_f32 v234, v234, v73
  v_cvt_pk_bf16_f32 v72, v72, v73
  v_exp_f32 v76, v76
  v_exp_f32 v77, v77
  v_mfma_f32_32x32x16_bf16 v[112:127], a[96:99], v[128:131], 0
  ds_read_b128 v[128:131], v216 offset:0
  v_add_f32 v234, v234, v74
  v_add_f32 v234, v234, v75
  v_cvt_pk_bf16_f32 v73, v74, v75
  v_exp_f32 v78, v78
  v_mfma_f32_32x32x16_bf16 v[112:127], a[100:103], v[132:135], v[112:127]
  ds_read_b128 v[132:135], v217 offset:0
  v_exp_f32 v79, v79
  v_add_f32 v234, v234, v76
  v_add_f32 v234, v234, v77
  v_cvt_pk_bf16_f32 v74, v76, v77
  v_mfma_f32_32x32x16_bf16 v[112:127], a[104:107], v[136:139], v[112:127]
  ds_read_b128 v[136:139], v218 offset:0
  v_exp_f32 v80, v80
  v_exp_f32 v81, v81
  v_add_f32 v234, v234, v78
  v_mfma_f32_32x32x16_bf16 v[112:127], a[108:111], v[140:143], v[112:127]
  ds_read_b128 v[140:143], v219 offset:0
  v_add_f32 v234, v234, v79
  v_cvt_pk_bf16_f32 v75, v78, v79
  v_exp_f32 v82, v82
  v_add_f32 v242, v236, v237
  v_mfma_f32_32x32x16_bf16 v[112:127], a[112:115], v[144:147], v[112:127]
  ds_read_b128 v[144:147], v220 offset:0
  ds_write_b128 v224, v[72:75] offset:33792
  v_mfma_f32_32x32x16_bf16 v[112:127], a[116:119], v[148:151], v[112:127]
  ds_read_b128 v[148:151], v221 offset:0
  v_exp_f32 v83, v83
  v_add_f32 v234, v234, v80
  v_add_f32 v234, v234, v81
  v_cvt_pk_bf16_f32 v80, v80, v81
  v_mfma_f32_32x32x16_bf16 v[112:127], a[120:123], v[152:155], v[112:127]
  ds_read_b128 v[152:155], v222 offset:0
  v_exp_f32 v84, v84
  v_exp_f32 v85, v85
  v_add_f32 v234, v234, v82
  v_mfma_f32_32x32x16_bf16 v[112:127], a[124:127], v[156:159], v[112:127]
  ds_read_b128 v[156:159], v223 offset:0
  v_add_f32 v234, v234, v83
  v_cvt_pk_bf16_f32 v81, v82, v83
  v_exp_f32 v86, v86
  v_add_f32 v238, v238, v239
  v_mfma_f32_32x32x16_bf16 v[192:207], a[128:131], v[0:3], 0
  ds_read_b128 v[160:163], v225 offset:0
  v_exp_f32 v87, v87
  v_add_f32 v234, v234, v84
  v_add_f32 v234, v234, v85
  v_cvt_pk_bf16_f32 v82, v84, v85
  v_mfma_f32_32x32x16_bf16 v[192:207], a[132:135], v[8:11], v[192:207]
  ds_read_b128 v[164:167], v225 offset:1024
  v_exp_f32 v88, v88
  v_exp_f32 v89, v89
  v_add_f32 v234, v234, v86
  v_mfma_f32_32x32x16_bf16 v[192:207], a[136:139], v[16:19], v[192:207]
  ds_read_b128 v[168:171], v225 offset:2048
  v_add_f32 v234, v234, v87
  v_cvt_pk_bf16_f32 v83, v86, v87
  v_exp_f32 v90, v90
  v_add_f32 v242, v242, v238
  v_mfma_f32_32x32x16_bf16 v[192:207], a[140:143], v[24:27], v[192:207]
  ds_read_b128 v[172:175], v225 offset:3072
  ds_write_b128 v224, v[80:83] offset:34816
  v_mfma_f32_32x32x16_bf16 v[192:207], a[144:147], v[32:35], v[192:207]
  ds_read_b128 v[176:179], v225 offset:4096
  v_exp_f32 v91, v91
  v_add_f32 v234, v234, v88
  v_add_f32 v234, v234, v89
  v_cvt_pk_bf16_f32 v88, v88, v89
  v_mfma_f32_32x32x16_bf16 v[192:207], a[148:151], v[40:43], v[192:207]
  ds_read_b128 v[180:183], v225 offset:5120
  v_exp_f32 v92, v92
  v_exp_f32 v93, v93
  v_add_f32 v234, v234, v90
  v_mfma_f32_32x32x16_bf16 v[192:207], a[152:155], v[48:51], v[192:207]
  ds_read_b128 v[184:187], v225 offset:6144
  v_add_f32 v234, v234, v91
  v_cvt_pk_bf16_f32 v89, v90, v91
  v_exp_f32 v94, v94
  s_add_u32 s21, s21, 8192
  v_mfma_f32_32x32x16_bf16 v[192:207], a[156:159], v[56:59], v[192:207]
  ds_read_b128 v[188:191], v225 offset:7168
  v_exp_f32 v95, v95
  v_add_f32 v234, v234, v92
  v_add_f32 v234, v234, v93
  s_waitcnt lgkmcnt(5)
  v_mfma_f32_32x32x16_bf16 v[192:207], a[160:163], v[160:163], v[192:207]
  ds_read_b128 v[160:163], v226 offset:0
  v_cvt_pk_bf16_f32 v90, v92, v93
  v_rcp_f32 v240, v242
  v_exp_f32 v96, v96
  v_mfma_f32_32x32x16_bf16 v[192:207], a[164:167], v[164:167], v[192:207]
  ds_read_b128 v[164:167], v226 offset:1024
  v_exp_f32 v97, v97
  v_add_f32 v234, v234, v94
  v_add_f32 v234, v234, v95
  v_cvt_pk_bf16_f32 v91, v94, v95
  v_mfma_f32_32x32x16_bf16 v[192:207], a[168:171], v[168:171], v[192:207]
  ds_read_b128 v[168:171], v226 offset:2048
  ds_write_b128 v224, v[88:91] offset:35840
  v_mfma_f32_32x32x16_bf16 v[192:207], a[172:175], v[172:175], v[192:207]
  ds_read_b128 v[172:175], v226 offset:3072
  v_exp_f32 v98, v98
  v_exp_f32 v99, v99
  s_waitcnt lgkmcnt(5)
  v_mfma_f32_32x32x16_bf16 v[192:207], a[176:179], v[176:179], v[192:207]
  ds_read_b128 v[176:179], v226 offset:4096
  v_add_f32 v234, v234, v96
  v_add_f32 v234, v234, v97
  v_cvt_pk_bf16_f32 v96, v96, v97
  v_exp_f32 v100, v100
  v_mfma_f32_32x32x16_bf16 v[192:207], a[180:183], v[180:183], v[192:207]
  ds_read_b128 v[180:183], v226 offset:5120
  v_exp_f32 v101, v101
  v_add_f32 v234, v234, v98
  v_add_f32 v234, v234, v99
  v_cvt_pk_bf16_f32 v97, v98, v99
  v_mfma_f32_32x32x16_bf16 v[192:207], a[184:187], v[184:187], v[192:207]
  ds_read_b128 v[184:187], v226 offset:6144
  v_exp_f32 v102, v102
  v_exp_f32 v103, v103
  v_add_f32 v234, v234, v100
  v_mfma_f32_32x32x16_bf16 v[192:207], a[188:191], v[188:191], v[192:207]
  ds_read_b128 v[188:191], v226 offset:7168
  v_add_f32 v234, v234, v101
  v_cvt_pk_bf16_f32 v98, v100, v101
  v_exp_f32 v104, v104
  s_waitcnt lgkmcnt(4)
  v_mfma_f32_32x32x16_bf16 v[192:207], a[192:195], v[160:163], v[192:207]
  ds_read_b128 v[160:163], v227 offset:0
  v_exp_f32 v105, v105
  v_add_f32 v234, v234, v102
  v_add_f32 v234, v234, v103
  v_cvt_pk_bf16_f32 v99, v102, v103
  v_mfma_f32_32x32x16_bf16 v[192:207], a[196:199], v[164:167], v[192:207]
  ds_read_b128 v[164:167], v227 offset:1024
  ds_write_b128 v224, v[96:99] offset:36864
  v_mfma_f32_32x32x16_bf16 v[192:207], a[200:203], v[168:171], v[192:207]
  ds_read_b128 v[168:171], v227 offset:2048
  v_exp_f32 v106, v106
  v_exp_f32 v107, v107
  v_add_f32 v234, v234, v104
  v_mfma_f32_32x32x16_bf16 v[192:207], a[204:207], v[172:175], v[192:207]
  ds_read_b128 v[172:175], v227 offset:3072
  v_add_f32 v234, v234, v105
  v_cvt_pk_bf16_f32 v104, v104, v105
  v_exp_f32 v108, v108
  s_waitcnt lgkmcnt(5)
  v_mfma_f32_32x32x16_bf16 v[192:207], a[208:211], v[176:179], v[192:207]
  ds_read_b128 v[176:179], v227 offset:4096
  v_exp_f32 v109, v109
  v_add_f32 v234, v234, v106
  v_add_f32 v234, v234, v107
  v_cvt_pk_bf16_f32 v105, v106, v107
  v_mfma_f32_32x32x16_bf16 v[192:207], a[212:215], v[180:183], v[192:207]
  ds_read_b128 v[180:183], v227 offset:5120
  v_exp_f32 v110, v110
  v_exp_f32 v111, v111
  v_add_f32 v234, v234, v108
  v_mfma_f32_32x32x16_bf16 v[192:207], a[216:219], v[184:187], v[192:207]
  ds_read_b128 v[184:187], v227 offset:6144
  v_add_f32 v234, v234, v109
  v_cvt_pk_bf16_f32 v106, v108, v109
  v_exp_f32 v112, v112
  v_maximum3_f32 v243, v243, v242, v240
  v_mfma_f32_32x32x16_bf16 v[192:207], a[220:223], v[188:191], v[192:207]
  ds_read_b128 v[188:191], v227 offset:7168
  v_exp_f32 v113, v113
  v_add_f32 v234, v234, v110
  v_add_f32 v234, v234, v111
  s_waitcnt lgkmcnt(4)
  v_mfma_f32_32x32x16_bf16 v[192:207], a[224:227], v[160:163], v[192:207]
  v_cvt_pk_bf16_f32 v107, v110, v111
  v_exp_f32 v114, v114
  v_exp_f32 v115, v115
  v_add_f32 v234, v234, v112
  v_mfma_f32_32x32x16_bf16 v[192:207], a[228:231], v[164:167], v[192:207]
  ds_write_b128 v224, v[104:107] offset:37888
  v_add_f32 v234, v234, v113
  v_mfma_f32_32x32x16_bf16 v[192:207], a[232:235], v[168:171], v[192:207]
  v_cvt_pk_bf16_f32 v112, v112, v113
  v_exp_f32 v116, v116
  v_exp_f32 v117, v117
  v_add_f32 v234, v234, v114
  v_mfma_f32_32x32x16_bf16 v[192:207], a[236:239], v[172:175], v[192:207]
  v_add_f32 v234, v234, v115
  v_cvt_pk_bf16_f32 v113, v114, v115
  v_exp_f32 v118, v118
  s_add_u32 s22, s22, 8192
  s_waitcnt lgkmcnt(1)
  v_mfma_f32_32x32x16_bf16 v[192:207], a[240:243], v[176:179], v[192:207]
  v_exp_f32 v119, v119
  v_add_f32 v234, v234, v116
  v_add_f32 v234, v234, v117
  v_cvt_pk_bf16_f32 v114, v116, v117
  v_mfma_f32_32x32x16_bf16 v[192:207], a[244:247], v[180:183], v[192:207]
  v_exp_f32 v120, v120
  v_exp_f32 v121, v121
  v_add_f32 v234, v234, v118
  v_add_f32 v234, v234, v119
  v_mfma_f32_32x32x16_bf16 v[192:207], a[248:251], v[184:187], v[192:207]
  v_cvt_pk_bf16_f32 v115, v118, v119
  v_exp_f32 v122, v122
  v_exp_f32 v123, v123
  v_add_f32 v234, v234, v120
  v_mfma_f32_32x32x16_bf16 v[192:207], a[252:255], v[188:191], v[192:207]
  ds_write_b128 v224, v[112:115] offset:38912
  v_add_f32 v234, v234, v121
  v_mfma_f32_32x32x16_bf16 v[0:15], a[0:3], v[128:131], 0
  v_cvt_pk_bf16_f32 v120, v120, v121
  v_exp_f32 v124, v124
  v_exp_f32 v125, v125
  v_add_f32 v234, v234, v122
  v_mfma_f32_32x32x16_bf16 v[0:15], a[4:7], v[132:135], v[0:15]
  v_add_f32 v234, v234, v123
  v_cvt_pk_bf16_f32 v121, v122, v123
  v_exp_f32 v126, v126
  v_exp_f32 v127, v127
  v_mfma_f32_32x32x16_bf16 v[0:15], a[8:11], v[136:139], v[0:15]
  v_add_f32 v234, v234, v124
  v_add_f32 v234, v234, v125
  v_cvt_pk_bf16_f32 v122, v124, v125
  v_add_f32 v234, v234, v126
  v_add_f32 v234, v234, v127
  v_mfma_f32_32x32x16_bf16 v[0:15], a[12:15], v[140:143], v[0:15]
  v_mov_b32 v235, v234
  v_cvt_pk_bf16_f32 v123, v126, v127
  s_add_u32 m0, s24, 0
  v_permlane32_swap_b32 v235, v234
  v_add_f32 v234, v234, v235
  v_mfma_f32_32x32x16_bf16 v[0:15], a[16:19], v[144:147], v[0:15]
  ds_write_b128 v224, v[120:123] offset:39936
  v_mul_f32 v192, v192, v240
  v_mfma_f32_32x32x16_bf16 v[0:15], a[20:23], v[148:151], v[0:15]
  ds_write_b32 v228, v234 offset:512
  v_mul_f32 v193, v193, v240
  v_cvt_pk_bf16_f32 v208, v192, v193
  v_mul_f32 v194, v194, v240
  v_mul_f32 v195, v195, v240
  v_mfma_f32_32x32x16_bf16 v[0:15], a[24:27], v[152:155], v[0:15]
  v_cvt_pk_bf16_f32 v209, v194, v195
  v_mul_f32 v196, v196, v240
  v_mul_f32 v197, v197, v240
  v_cvt_pk_bf16_f32 v210, v196, v197
  v_mul_f32 v198, v198, v240
  v_mfma_f32_32x32x16_bf16 v[0:15], a[28:31], v[156:159], v[0:15]
  v_mul_f32 v199, v199, v240
  v_cvt_pk_bf16_f32 v211, v198, v199
  v_mul_f32 v200, v200, v240
  v_mul_f32 v201, v201, v240
  v_cvt_pk_bf16_f32 v212, v200, v201
  v_mfma_f32_32x32x16_bf16 v[16:31], a[32:35], v[128:131], 0
  ds_write_b128 v244, v[208:211] offset:0
  v_mul_f32 v202, v202, v240
  v_mfma_f32_32x32x16_bf16 v[16:31], a[36:39], v[132:135], v[16:31]
  v_mul_f32 v203, v203, v240
  v_cvt_pk_bf16_f32 v213, v202, v203
  v_mul_f32 v204, v204, v240
  v_mul_f32 v205, v205, v240
  v_cvt_pk_bf16_f32 v214, v204, v205
  v_mfma_f32_32x32x16_bf16 v[16:31], a[40:43], v[136:139], v[16:31]
  v_mul_f32 v206, v206, v240
  v_exp_f32 v0, v0
  v_mul_f32 v207, v207, v240
  v_exp_f32 v1, v1
  v_mfma_f32_32x32x16_bf16 v[16:31], a[44:47], v[140:143], v[16:31]
  v_cvt_pk_bf16_f32 v215, v206, v207
  v_exp_f32 v2, v2
  v_exp_f32 v3, v3
  v_add_f32 v233, v0, v1
  v_mfma_f32_32x32x16_bf16 v[16:31], a[48:51], v[144:147], v[16:31]
  ds_write_b128 v245, v[212:215] offset:0
  v_cvt_pk_bf16_f32 v0, v0, v1
  v_mfma_f32_32x32x16_bf16 v[16:31], a[52:55], v[148:151], v[16:31]
  v_exp_f32 v4, v4
  v_exp_f32 v5, v5
  v_add_f32 v233, v233, v2
  v_add_f32 v233, v233, v3
  v_mfma_f32_32x32x16_bf16 v[16:31], a[56:59], v[152:155], v[16:31]
  v_cvt_pk_bf16_f32 v1, v2, v3
  v_exp_f32 v6, v6
  v_exp_f32 v7, v7
  v_add_f32 v233, v233, v4
  v_mfma_f32_32x32x16_bf16 v[16:31], a[60:63], v[156:159], v[16:31]
  s_waitcnt vmcnt(6) lgkmcnt(0)
  s_barrier
  v_add_f32 v233, v233, v5
  v_mfma_f32_32x32x16_bf16 v[32:47], a[64:67], v[128:131], 0
  ds_read_b128 v[236:239], v229 offset:512
  buffer_load_dwordx4 v231, s[4:7], s21 offen nt lds
  v_cvt_pk_bf16_f32 v2, v4, v5
  v_mfma_f32_32x32x16_bf16 v[32:47], a[68:71], v[132:135], v[32:47]
  ds_read_b128 v[208:211], v246 offset:0
  buffer_load_dwordx4 v232, s[4:7], s21 offen offset:1024 nt lds
  v_exp_f32 v8, v8
  v_mfma_f32_32x32x16_bf16 v[32:47], a[72:75], v[136:139], v[32:47]
  ds_read_b128 v[212:215], v247 offset:0
  v_exp_f32 v9, v9
  v_add_f32 v233, v233, v6
  v_add_f32 v233, v233, v7
  v_cvt_pk_bf16_f32 v3, v6, v7
  v_mfma_f32_32x32x16_bf16 v[32:47], a[76:79], v[140:143], v[32:47]
  v_exp_f32 v10, v10
  v_exp_f32 v11, v11
  v_mfma_f32_32x32x16_bf16 v[32:47], a[80:83], v[144:147], v[32:47]
  s_waitcnt lgkmcnt(1)
  buffer_store_dwordx4 v[208:211], v248, s[16:19], s22 offen sc1
  v_mfma_f32_32x32x16_bf16 v[32:47], a[84:87], v[148:151], v[32:47]
  ds_write_b128 v224, v[0:3] offset:0
  v_add_f32 v233, v233, v8
  v_mfma_f32_32x32x16_bf16 v[32:47], a[88:91], v[152:155], v[32:47]
  s_waitcnt lgkmcnt(1)
  buffer_store_dwordx4 v[212:215], v248, s[16:19], s22 offen offset:1024 sc1
  v_mfma_f32_32x32x16_bf16 v[32:47], a[92:95], v[156:159], v[32:47]
  v_add_f32 v233, v233, v9
  v_cvt_pk_bf16_f32 v8, v8, v9
  v_exp_f32 v12, v12
  v_exp_f32 v13, v13
  v_mfma_f32_32x32x16_bf16 v[48:63], a[96:99], v[128:131], 0
  ds_read_b128 v[128:131], v216 offset:8192
  v_add_f32 v233, v233, v10
  v_add_f32 v233, v233, v11
  v_cvt_pk_bf16_f32 v9, v10, v11
  v_exp_f32 v14, v14
  v_mfma_f32_32x32x16_bf16 v[48:63], a[100:103], v[132:135], v[48:63]
  ds_read_b128 v[132:135], v217 offset:8192
  v_exp_f32 v15, v15
  v_add_f32 v233, v233, v12
  v_add_f32 v233, v233, v13
  v_cvt_pk_bf16_f32 v10, v12, v13
  v_mfma_f32_32x32x16_bf16 v[48:63], a[104:107], v[136:139], v[48:63]
  ds_read_b128 v[136:139], v218 offset:8192
  v_exp_f32 v16, v16
  v_exp_f32 v17, v17
  v_add_f32 v233, v233, v14
  v_mfma_f32_32x32x16_bf16 v[48:63], a[108:111], v[140:143], v[48:63]
  ds_read_b128 v[140:143], v219 offset:8192
  v_add_f32 v233, v233, v15
  v_cvt_pk_bf16_f32 v11, v14, v15
  v_exp_f32 v18, v18
  v_add_f32 v242, v236, v237
  v_mfma_f32_32x32x16_bf16 v[48:63], a[112:115], v[144:147], v[48:63]
  ds_read_b128 v[144:147], v220 offset:8192
  ds_write_b128 v224, v[8:11] offset:1024
  v_mfma_f32_32x32x16_bf16 v[48:63], a[116:119], v[148:151], v[48:63]
  ds_read_b128 v[148:151], v221 offset:8192
  v_exp_f32 v19, v19
  v_add_f32 v233, v233, v16
  v_add_f32 v233, v233, v17
  v_cvt_pk_bf16_f32 v16, v16, v17
  v_mfma_f32_32x32x16_bf16 v[48:63], a[120:123], v[152:155], v[48:63]
  ds_read_b128 v[152:155], v222 offset:8192
  v_exp_f32 v20, v20
  v_exp_f32 v21, v21
  v_add_f32 v233, v233, v18
  v_mfma_f32_32x32x16_bf16 v[48:63], a[124:127], v[156:159], v[48:63]
  ds_read_b128 v[156:159], v223 offset:8192
  v_add_f32 v233, v233, v19
  v_cvt_pk_bf16_f32 v17, v18, v19
  v_exp_f32 v22, v22
  v_add_f32 v238, v238, v239
  v_mfma_f32_32x32x16_bf16 v[192:207], a[128:131], v[64:67], 0
  ds_read_b128 v[160:163], v225 offset:32768
  v_exp_f32 v23, v23
  v_add_f32 v233, v233, v20
  v_add_f32 v233, v233, v21
  v_cvt_pk_bf16_f32 v18, v20, v21
  v_mfma_f32_32x32x16_bf16 v[192:207], a[132:135], v[72:75], v[192:207]
  ds_read_b128 v[164:167], v225 offset:33792
  v_exp_f32 v24, v24
  v_exp_f32 v25, v25
  v_add_f32 v233, v233, v22
  v_mfma_f32_32x32x16_bf16 v[192:207], a[136:139], v[80:83], v[192:207]
  ds_read_b128 v[168:171], v225 offset:34816
  v_add_f32 v233, v233, v23
  v_cvt_pk_bf16_f32 v19, v22, v23
  v_exp_f32 v26, v26
  v_add_f32 v242, v242, v238
  v_mfma_f32_32x32x16_bf16 v[192:207], a[140:143], v[88:91], v[192:207]
  ds_read_b128 v[172:175], v225 offset:35840
  ds_write_b128 v224, v[16:19] offset:2048
  v_mfma_f32_32x32x16_bf16 v[192:207], a[144:147], v[96:99], v[192:207]
  ds_read_b128 v[176:179], v225 offset:36864
  v_exp_f32 v27, v27
  v_add_f32 v233, v233, v24
  v_add_f32 v233, v233, v25
  v_cvt_pk_bf16_f32 v24, v24, v25
  v_mfma_f32_32x32x16_bf16 v[192:207], a[148:151], v[104:107], v[192:207]
  ds_read_b128 v[180:183], v225 offset:37888
  v_exp_f32 v28, v28
  v_exp_f32 v29, v29
  v_add_f32 v233, v233, v26
  v_mfma_f32_32x32x16_bf16 v[192:207], a[152:155], v[112:115], v[192:207]
  ds_read_b128 v[184:187], v225 offset:38912
  v_add_f32 v233, v233, v27
  v_cvt_pk_bf16_f32 v25, v26, v27
  v_exp_f32 v30, v30
  s_add_u32 s21, s21, 8192
  v_mfma_f32_32x32x16_bf16 v[192:207], a[156:159], v[120:123], v[192:207]
  ds_read_b128 v[188:191], v225 offset:39936
  v_exp_f32 v31, v31
  v_add_f32 v233, v233, v28
  v_add_f32 v233, v233, v29
  s_waitcnt lgkmcnt(5)
  v_mfma_f32_32x32x16_bf16 v[192:207], a[160:163], v[160:163], v[192:207]
  ds_read_b128 v[160:163], v226 offset:32768
  v_cvt_pk_bf16_f32 v26, v28, v29
  v_rcp_f32 v241, v242
  v_exp_f32 v32, v32
  v_mfma_f32_32x32x16_bf16 v[192:207], a[164:167], v[164:167], v[192:207]
  ds_read_b128 v[164:167], v226 offset:33792
  v_exp_f32 v33, v33
  v_add_f32 v233, v233, v30
  v_add_f32 v233, v233, v31
  v_cvt_pk_bf16_f32 v27, v30, v31
  v_mfma_f32_32x32x16_bf16 v[192:207], a[168:171], v[168:171], v[192:207]
  ds_read_b128 v[168:171], v226 offset:34816
  ds_write_b128 v224, v[24:27] offset:3072
  v_mfma_f32_32x32x16_bf16 v[192:207], a[172:175], v[172:175], v[192:207]
  ds_read_b128 v[172:175], v226 offset:35840
  v_exp_f32 v34, v34
  v_exp_f32 v35, v35
  s_waitcnt lgkmcnt(5)
  v_mfma_f32_32x32x16_bf16 v[192:207], a[176:179], v[176:179], v[192:207]
  ds_read_b128 v[176:179], v226 offset:36864
  v_add_f32 v233, v233, v32
  v_add_f32 v233, v233, v33
  v_cvt_pk_bf16_f32 v32, v32, v33
  v_exp_f32 v36, v36
  v_mfma_f32_32x32x16_bf16 v[192:207], a[180:183], v[180:183], v[192:207]
  ds_read_b128 v[180:183], v226 offset:37888
  v_exp_f32 v37, v37
  v_add_f32 v233, v233, v34
  v_add_f32 v233, v233, v35
  v_cvt_pk_bf16_f32 v33, v34, v35
  v_mfma_f32_32x32x16_bf16 v[192:207], a[184:187], v[184:187], v[192:207]
  ds_read_b128 v[184:187], v226 offset:38912
  v_exp_f32 v38, v38
  v_exp_f32 v39, v39
  v_add_f32 v233, v233, v36
  v_mfma_f32_32x32x16_bf16 v[192:207], a[188:191], v[188:191], v[192:207]
  ds_read_b128 v[188:191], v226 offset:39936
  v_add_f32 v233, v233, v37
  v_cvt_pk_bf16_f32 v34, v36, v37
  v_exp_f32 v40, v40
  s_waitcnt lgkmcnt(4)
  v_mfma_f32_32x32x16_bf16 v[192:207], a[192:195], v[160:163], v[192:207]
  ds_read_b128 v[160:163], v227 offset:32768
  v_exp_f32 v41, v41
  v_add_f32 v233, v233, v38
  v_add_f32 v233, v233, v39
  v_cvt_pk_bf16_f32 v35, v38, v39
  v_mfma_f32_32x32x16_bf16 v[192:207], a[196:199], v[164:167], v[192:207]
  ds_read_b128 v[164:167], v227 offset:33792
  ds_write_b128 v224, v[32:35] offset:4096
  v_mfma_f32_32x32x16_bf16 v[192:207], a[200:203], v[168:171], v[192:207]
  ds_read_b128 v[168:171], v227 offset:34816
  v_exp_f32 v42, v42
  v_exp_f32 v43, v43
  v_add_f32 v233, v233, v40
  v_mfma_f32_32x32x16_bf16 v[192:207], a[204:207], v[172:175], v[192:207]
  ds_read_b128 v[172:175], v227 offset:35840
  v_add_f32 v233, v233, v41
  v_cvt_pk_bf16_f32 v40, v40, v41
  v_exp_f32 v44, v44
  s_waitcnt lgkmcnt(5)
  v_mfma_f32_32x32x16_bf16 v[192:207], a[208:211], v[176:179], v[192:207]
  ds_read_b128 v[176:179], v227 offset:36864
  v_exp_f32 v45, v45
  v_add_f32 v233, v233, v42
  v_add_f32 v233, v233, v43
  v_cvt_pk_bf16_f32 v41, v42, v43
  v_mfma_f32_32x32x16_bf16 v[192:207], a[212:215], v[180:183], v[192:207]
  ds_read_b128 v[180:183], v227 offset:37888
  v_exp_f32 v46, v46
  v_exp_f32 v47, v47
  v_add_f32 v233, v233, v44
  v_mfma_f32_32x32x16_bf16 v[192:207], a[216:219], v[184:187], v[192:207]
  ds_read_b128 v[184:187], v227 offset:38912
  v_add_f32 v233, v233, v45
  v_cvt_pk_bf16_f32 v42, v44, v45
  v_exp_f32 v48, v48
  v_maximum3_f32 v243, v243, v242, v241
  v_mfma_f32_32x32x16_bf16 v[192:207], a[220:223], v[188:191], v[192:207]
  ds_read_b128 v[188:191], v227 offset:39936
  v_exp_f32 v49, v49
  v_add_f32 v233, v233, v46
  v_add_f32 v233, v233, v47
  s_waitcnt lgkmcnt(4)
  v_mfma_f32_32x32x16_bf16 v[192:207], a[224:227], v[160:163], v[192:207]
  v_cvt_pk_bf16_f32 v43, v46, v47
  v_exp_f32 v50, v50
  v_exp_f32 v51, v51
  v_add_f32 v233, v233, v48
  v_mfma_f32_32x32x16_bf16 v[192:207], a[228:231], v[164:167], v[192:207]
  ds_write_b128 v224, v[40:43] offset:5120
  v_add_f32 v233, v233, v49
  v_mfma_f32_32x32x16_bf16 v[192:207], a[232:235], v[168:171], v[192:207]
  v_cvt_pk_bf16_f32 v48, v48, v49
  v_exp_f32 v52, v52
  v_exp_f32 v53, v53
  v_add_f32 v233, v233, v50
  v_mfma_f32_32x32x16_bf16 v[192:207], a[236:239], v[172:175], v[192:207]
  v_add_f32 v233, v233, v51
  v_cvt_pk_bf16_f32 v49, v50, v51
  v_exp_f32 v54, v54
  s_add_u32 s22, s22, 8192
  s_waitcnt lgkmcnt(1)
  v_mfma_f32_32x32x16_bf16 v[192:207], a[240:243], v[176:179], v[192:207]
  v_exp_f32 v55, v55
  v_add_f32 v233, v233, v52
  v_add_f32 v233, v233, v53
  v_cvt_pk_bf16_f32 v50, v52, v53
  v_mfma_f32_32x32x16_bf16 v[192:207], a[244:247], v[180:183], v[192:207]
  v_exp_f32 v56, v56
  v_exp_f32 v57, v57
  v_add_f32 v233, v233, v54
  v_add_f32 v233, v233, v55
  v_mfma_f32_32x32x16_bf16 v[192:207], a[248:251], v[184:187], v[192:207]
  v_cvt_pk_bf16_f32 v51, v54, v55
  v_exp_f32 v58, v58
  v_exp_f32 v59, v59
  v_add_f32 v233, v233, v56
  v_mfma_f32_32x32x16_bf16 v[192:207], a[252:255], v[188:191], v[192:207]
  ds_write_b128 v224, v[48:51] offset:6144
  v_add_f32 v233, v233, v57
  v_mfma_f32_32x32x16_bf16 v[64:79], a[0:3], v[128:131], 0
  v_cvt_pk_bf16_f32 v56, v56, v57
  v_exp_f32 v60, v60
  v_exp_f32 v61, v61
  v_add_f32 v233, v233, v58
  v_mfma_f32_32x32x16_bf16 v[64:79], a[4:7], v[132:135], v[64:79]
  v_add_f32 v233, v233, v59
  v_cvt_pk_bf16_f32 v57, v58, v59
  v_exp_f32 v62, v62
  v_exp_f32 v63, v63
  v_mfma_f32_32x32x16_bf16 v[64:79], a[8:11], v[136:139], v[64:79]
  v_add_f32 v233, v233, v60
  v_add_f32 v233, v233, v61
  v_cvt_pk_bf16_f32 v58, v60, v61
  v_add_f32 v233, v233, v62
  v_add_f32 v233, v233, v63
  v_mfma_f32_32x32x16_bf16 v[64:79], a[12:15], v[140:143], v[64:79]
  v_mov_b32 v235, v233
  v_cvt_pk_bf16_f32 v59, v62, v63
  s_add_u32 m0, s24, 8192
  v_permlane32_swap_b32 v235, v233
  v_add_f32 v233, v233, v235
  v_mfma_f32_32x32x16_bf16 v[64:79], a[16:19], v[144:147], v[64:79]
  ds_write_b128 v224, v[56:59] offset:7168
  v_mul_f32 v192, v192, v241
  v_mfma_f32_32x32x16_bf16 v[64:79], a[20:23], v[148:151], v[64:79]
  ds_write_b32 v228, v233 offset:0
  v_mul_f32 v193, v193, v241
  v_cvt_pk_bf16_f32 v208, v192, v193
  v_mul_f32 v194, v194, v241
  v_mul_f32 v195, v195, v241
  v_mfma_f32_32x32x16_bf16 v[64:79], a[24:27], v[152:155], v[64:79]
  v_cvt_pk_bf16_f32 v209, v194, v195
  v_mul_f32 v196, v196, v241
  v_mul_f32 v197, v197, v241
  v_cvt_pk_bf16_f32 v210, v196, v197
  v_mul_f32 v198, v198, v241
  v_mfma_f32_32x32x16_bf16 v[64:79], a[28:31], v[156:159], v[64:79]
  v_mul_f32 v199, v199, v241
  v_cvt_pk_bf16_f32 v211, v198, v199
  v_mul_f32 v200, v200, v241
  v_mul_f32 v201, v201, v241
  v_cvt_pk_bf16_f32 v212, v200, v201
  v_mfma_f32_32x32x16_bf16 v[80:95], a[32:35], v[128:131], 0
  ds_write_b128 v244, v[208:211] offset:8192
  v_mul_f32 v202, v202, v241
  v_mfma_f32_32x32x16_bf16 v[80:95], a[36:39], v[132:135], v[80:95]
  v_mul_f32 v203, v203, v241
  v_cvt_pk_bf16_f32 v213, v202, v203
  v_mul_f32 v204, v204, v241
  v_mul_f32 v205, v205, v241
  v_cvt_pk_bf16_f32 v214, v204, v205
  v_mfma_f32_32x32x16_bf16 v[80:95], a[40:43], v[136:139], v[80:95]
  v_mul_f32 v206, v206, v241
  v_exp_f32 v64, v64
  v_mul_f32 v207, v207, v241
  v_exp_f32 v65, v65
  v_mfma_f32_32x32x16_bf16 v[80:95], a[44:47], v[140:143], v[80:95]
  v_cvt_pk_bf16_f32 v215, v206, v207
  v_exp_f32 v66, v66
  v_exp_f32 v67, v67
  v_add_f32 v234, v64, v65
  v_mfma_f32_32x32x16_bf16 v[80:95], a[48:51], v[144:147], v[80:95]
  ds_write_b128 v245, v[212:215] offset:8192
  v_cvt_pk_bf16_f32 v64, v64, v65
  v_mfma_f32_32x32x16_bf16 v[80:95], a[52:55], v[148:151], v[80:95]
  v_exp_f32 v68, v68
  v_exp_f32 v69, v69
  v_add_f32 v234, v234, v66
  v_add_f32 v234, v234, v67
  v_mfma_f32_32x32x16_bf16 v[80:95], a[56:59], v[152:155], v[80:95]
  v_cvt_pk_bf16_f32 v65, v66, v67
  v_exp_f32 v70, v70
  v_exp_f32 v71, v71
  v_add_f32 v234, v234, v68
  v_mfma_f32_32x32x16_bf16 v[80:95], a[60:63], v[156:159], v[80:95]
  s_waitcnt vmcnt(6) lgkmcnt(0)
  s_barrier
  v_add_f32 v234, v234, v69
  v_mfma_f32_32x32x16_bf16 v[96:111], a[64:67], v[128:131], 0
  ds_read_b128 v[236:239], v229 offset:0
  buffer_load_dwordx4 v231, s[4:7], s21 offen nt lds
  v_cvt_pk_bf16_f32 v66, v68, v69
  v_mfma_f32_32x32x16_bf16 v[96:111], a[68:71], v[132:135], v[96:111]
  ds_read_b128 v[208:211], v246 offset:8192
  buffer_load_dwordx4 v232, s[4:7], s21 offen offset:1024 nt lds
  v_exp_f32 v72, v72
  v_mfma_f32_32x32x16_bf16 v[96:111], a[72:75], v[136:139], v[96:111]
  ds_read_b128 v[212:215], v247 offset:8192
  v_exp_f32 v73, v73
  v_add_f32 v234, v234, v70
  v_add_f32 v234, v234, v71
  v_cvt_pk_bf16_f32 v67, v70, v71
  v_mfma_f32_32x32x16_bf16 v[96:111], a[76:79], v[140:143], v[96:111]
  v_exp_f32 v74, v74
  v_exp_f32 v75, v75
  v_mfma_f32_32x32x16_bf16 v[96:111], a[80:83], v[144:147], v[96:111]
  s_waitcnt lgkmcnt(1)
  buffer_store_dwordx4 v[208:211], v248, s[16:19], s22 offen sc1
  v_mfma_f32_32x32x16_bf16 v[96:111], a[84:87], v[148:151], v[96:111]
  ds_write_b128 v224, v[64:67] offset:32768
  v_add_f32 v234, v234, v72
  v_mfma_f32_32x32x16_bf16 v[96:111], a[88:91], v[152:155], v[96:111]
  s_waitcnt lgkmcnt(1)
  buffer_store_dwordx4 v[212:215], v248, s[16:19], s22 offen offset:1024 sc1
  v_mfma_f32_32x32x16_bf16 v[96:111], a[92:95], v[156:159], v[96:111]
  v_add_f32 v234, v234, v73
  v_cvt_pk_bf16_f32 v72, v72, v73
  v_exp_f32 v76, v76
  v_exp_f32 v77, v77
  v_mfma_f32_32x32x16_bf16 v[112:127], a[96:99], v[128:131], 0
  ds_read_b128 v[128:131], v216 offset:16384
  v_add_f32 v234, v234, v74
  v_add_f32 v234, v234, v75
  v_cvt_pk_bf16_f32 v73, v74, v75
  v_exp_f32 v78, v78
  v_mfma_f32_32x32x16_bf16 v[112:127], a[100:103], v[132:135], v[112:127]
  ds_read_b128 v[132:135], v217 offset:16384
  v_exp_f32 v79, v79
  v_add_f32 v234, v234, v76
  v_add_f32 v234, v234, v77
  v_cvt_pk_bf16_f32 v74, v76, v77
  v_mfma_f32_32x32x16_bf16 v[112:127], a[104:107], v[136:139], v[112:127]
  ds_read_b128 v[136:139], v218 offset:16384
  v_exp_f32 v80, v80
  v_exp_f32 v81, v81
  v_add_f32 v234, v234, v78
  v_mfma_f32_32x32x16_bf16 v[112:127], a[108:111], v[140:143], v[112:127]
  ds_read_b128 v[140:143], v219 offset:16384
  v_add_f32 v234, v234, v79
  v_cvt_pk_bf16_f32 v75, v78, v79
  v_exp_f32 v82, v82
  v_add_f32 v242, v236, v237
  v_mfma_f32_32x32x16_bf16 v[112:127], a[112:115], v[144:147], v[112:127]
  ds_read_b128 v[144:147], v220 offset:16384
  ds_write_b128 v224, v[72:75] offset:33792
  v_mfma_f32_32x32x16_bf16 v[112:127], a[116:119], v[148:151], v[112:127]
  ds_read_b128 v[148:151], v221 offset:16384
  v_exp_f32 v83, v83
  v_add_f32 v234, v234, v80
  v_add_f32 v234, v234, v81
  v_cvt_pk_bf16_f32 v80, v80, v81
  v_mfma_f32_32x32x16_bf16 v[112:127], a[120:123], v[152:155], v[112:127]
  ds_read_b128 v[152:155], v222 offset:16384
  v_exp_f32 v84, v84
  v_exp_f32 v85, v85
  v_add_f32 v234, v234, v82
  v_mfma_f32_32x32x16_bf16 v[112:127], a[124:127], v[156:159], v[112:127]
  ds_read_b128 v[156:159], v223 offset:16384
  v_add_f32 v234, v234, v83
  v_cvt_pk_bf16_f32 v81, v82, v83
  v_exp_f32 v86, v86
  v_add_f32 v238, v238, v239
  v_mfma_f32_32x32x16_bf16 v[192:207], a[128:131], v[0:3], 0
  ds_read_b128 v[160:163], v225 offset:0
  v_exp_f32 v87, v87
  v_add_f32 v234, v234, v84
  v_add_f32 v234, v234, v85
  v_cvt_pk_bf16_f32 v82, v84, v85
  v_mfma_f32_32x32x16_bf16 v[192:207], a[132:135], v[8:11], v[192:207]
  ds_read_b128 v[164:167], v225 offset:1024
  v_exp_f32 v88, v88
  v_exp_f32 v89, v89
  v_add_f32 v234, v234, v86
  v_mfma_f32_32x32x16_bf16 v[192:207], a[136:139], v[16:19], v[192:207]
  ds_read_b128 v[168:171], v225 offset:2048
  v_add_f32 v234, v234, v87
  v_cvt_pk_bf16_f32 v83, v86, v87
  v_exp_f32 v90, v90
  v_add_f32 v242, v242, v238
  v_mfma_f32_32x32x16_bf16 v[192:207], a[140:143], v[24:27], v[192:207]
  ds_read_b128 v[172:175], v225 offset:3072
  ds_write_b128 v224, v[80:83] offset:34816
  v_mfma_f32_32x32x16_bf16 v[192:207], a[144:147], v[32:35], v[192:207]
  ds_read_b128 v[176:179], v225 offset:4096
  v_exp_f32 v91, v91
  v_add_f32 v234, v234, v88
  v_add_f32 v234, v234, v89
  v_cvt_pk_bf16_f32 v88, v88, v89
  v_mfma_f32_32x32x16_bf16 v[192:207], a[148:151], v[40:43], v[192:207]
  ds_read_b128 v[180:183], v225 offset:5120
  v_exp_f32 v92, v92
  v_exp_f32 v93, v93
  v_add_f32 v234, v234, v90
  v_mfma_f32_32x32x16_bf16 v[192:207], a[152:155], v[48:51], v[192:207]
  ds_read_b128 v[184:187], v225 offset:6144
  v_add_f32 v234, v234, v91
  v_cvt_pk_bf16_f32 v89, v90, v91
  v_exp_f32 v94, v94
  s_add_u32 s21, s21, 8192
  v_mfma_f32_32x32x16_bf16 v[192:207], a[156:159], v[56:59], v[192:207]
  ds_read_b128 v[188:191], v225 offset:7168
  v_exp_f32 v95, v95
  v_add_f32 v234, v234, v92
  v_add_f32 v234, v234, v93
  s_waitcnt lgkmcnt(5)
  v_mfma_f32_32x32x16_bf16 v[192:207], a[160:163], v[160:163], v[192:207]
  ds_read_b128 v[160:163], v226 offset:0
  v_cvt_pk_bf16_f32 v90, v92, v93
  v_rcp_f32 v240, v242
  v_exp_f32 v96, v96
  v_mfma_f32_32x32x16_bf16 v[192:207], a[164:167], v[164:167], v[192:207]
  ds_read_b128 v[164:167], v226 offset:1024
  v_exp_f32 v97, v97
  v_add_f32 v234, v234, v94
  v_add_f32 v234, v234, v95
  v_cvt_pk_bf16_f32 v91, v94, v95
  v_mfma_f32_32x32x16_bf16 v[192:207], a[168:171], v[168:171], v[192:207]
  ds_read_b128 v[168:171], v226 offset:2048
  ds_write_b128 v224, v[88:91] offset:35840
  v_mfma_f32_32x32x16_bf16 v[192:207], a[172:175], v[172:175], v[192:207]
  ds_read_b128 v[172:175], v226 offset:3072
  v_exp_f32 v98, v98
  v_exp_f32 v99, v99
  s_waitcnt lgkmcnt(5)
  v_mfma_f32_32x32x16_bf16 v[192:207], a[176:179], v[176:179], v[192:207]
  ds_read_b128 v[176:179], v226 offset:4096
  v_add_f32 v234, v234, v96
  v_add_f32 v234, v234, v97
  v_cvt_pk_bf16_f32 v96, v96, v97
  v_exp_f32 v100, v100
  v_mfma_f32_32x32x16_bf16 v[192:207], a[180:183], v[180:183], v[192:207]
  ds_read_b128 v[180:183], v226 offset:5120
  v_exp_f32 v101, v101
  v_add_f32 v234, v234, v98
  v_add_f32 v234, v234, v99
  v_cvt_pk_bf16_f32 v97, v98, v99
  v_mfma_f32_32x32x16_bf16 v[192:207], a[184:187], v[184:187], v[192:207]
  ds_read_b128 v[184:187], v226 offset:6144
  v_exp_f32 v102, v102
  v_exp_f32 v103, v103
  v_add_f32 v234, v234, v100
  v_mfma_f32_32x32x16_bf16 v[192:207], a[188:191], v[188:191], v[192:207]
  ds_read_b128 v[188:191], v226 offset:7168
  v_add_f32 v234, v234, v101
  v_cvt_pk_bf16_f32 v98, v100, v101
  v_exp_f32 v104, v104
  s_waitcnt lgkmcnt(4)
  v_mfma_f32_32x32x16_bf16 v[192:207], a[192:195], v[160:163], v[192:207]
  ds_read_b128 v[160:163], v227 offset:0
  v_exp_f32 v105, v105
  v_add_f32 v234, v234, v102
  v_add_f32 v234, v234, v103
  v_cvt_pk_bf16_f32 v99, v102, v103
  v_mfma_f32_32x32x16_bf16 v[192:207], a[196:199], v[164:167], v[192:207]
  ds_read_b128 v[164:167], v227 offset:1024
  ds_write_b128 v224, v[96:99] offset:36864
  v_mfma_f32_32x32x16_bf16 v[192:207], a[200:203], v[168:171], v[192:207]
  ds_read_b128 v[168:171], v227 offset:2048
  v_exp_f32 v106, v106
  v_exp_f32 v107, v107
  v_add_f32 v234, v234, v104
  v_mfma_f32_32x32x16_bf16 v[192:207], a[204:207], v[172:175], v[192:207]
  ds_read_b128 v[172:175], v227 offset:3072
  v_add_f32 v234, v234, v105
  v_cvt_pk_bf16_f32 v104, v104, v105
  v_exp_f32 v108, v108
  s_waitcnt lgkmcnt(5)
  v_mfma_f32_32x32x16_bf16 v[192:207], a[208:211], v[176:179], v[192:207]
  ds_read_b128 v[176:179], v227 offset:4096
  v_exp_f32 v109, v109
  v_add_f32 v234, v234, v106
  v_add_f32 v234, v234, v107
  v_cvt_pk_bf16_f32 v105, v106, v107
  v_mfma_f32_32x32x16_bf16 v[192:207], a[212:215], v[180:183], v[192:207]
  ds_read_b128 v[180:183], v227 offset:5120
  v_exp_f32 v110, v110
  v_exp_f32 v111, v111
  v_add_f32 v234, v234, v108
  v_mfma_f32_32x32x16_bf16 v[192:207], a[216:219], v[184:187], v[192:207]
  ds_read_b128 v[184:187], v227 offset:6144
  v_add_f32 v234, v234, v109
  v_cvt_pk_bf16_f32 v106, v108, v109
  v_exp_f32 v112, v112
  v_maximum3_f32 v243, v243, v242, v240
  v_mfma_f32_32x32x16_bf16 v[192:207], a[220:223], v[188:191], v[192:207]
  ds_read_b128 v[188:191], v227 offset:7168
  v_exp_f32 v113, v113
  v_add_f32 v234, v234, v110
  v_add_f32 v234, v234, v111
  s_waitcnt lgkmcnt(4)
  v_mfma_f32_32x32x16_bf16 v[192:207], a[224:227], v[160:163], v[192:207]
  v_cvt_pk_bf16_f32 v107, v110, v111
  v_exp_f32 v114, v114
  v_exp_f32 v115, v115
  v_add_f32 v234, v234, v112
  v_mfma_f32_32x32x16_bf16 v[192:207], a[228:231], v[164:167], v[192:207]
  ds_write_b128 v224, v[104:107] offset:37888
  v_add_f32 v234, v234, v113
  v_mfma_f32_32x32x16_bf16 v[192:207], a[232:235], v[168:171], v[192:207]
  v_cvt_pk_bf16_f32 v112, v112, v113
  v_exp_f32 v116, v116
  v_exp_f32 v117, v117
  v_add_f32 v234, v234, v114
  v_mfma_f32_32x32x16_bf16 v[192:207], a[236:239], v[172:175], v[192:207]
  v_add_f32 v234, v234, v115
  v_cvt_pk_bf16_f32 v113, v114, v115
  v_exp_f32 v118, v118
  s_add_u32 s22, s22, 8192
  s_waitcnt lgkmcnt(1)
  v_mfma_f32_32x32x16_bf16 v[192:207], a[240:243], v[176:179], v[192:207]
  v_exp_f32 v119, v119
  v_add_f32 v234, v234, v116
  v_add_f32 v234, v234, v117
  v_cvt_pk_bf16_f32 v114, v116, v117
  v_mfma_f32_32x32x16_bf16 v[192:207], a[244:247], v[180:183], v[192:207]
  v_exp_f32 v120, v120
  v_exp_f32 v121, v121
  v_add_f32 v234, v234, v118
  v_add_f32 v234, v234, v119
  v_mfma_f32_32x32x16_bf16 v[192:207], a[248:251], v[184:187], v[192:207]
  v_cvt_pk_bf16_f32 v115, v118, v119
  v_exp_f32 v122, v122
  v_exp_f32 v123, v123
  v_add_f32 v234, v234, v120
  v_mfma_f32_32x32x16_bf16 v[192:207], a[252:255], v[188:191], v[192:207]
  ds_write_b128 v224, v[112:115] offset:38912
  v_add_f32 v234, v234, v121
  s_sub_u32 s23, s23, 1
  s_cmp_lg_u32 s23, 0
  s_cbranch_scc1 L_loop
  v_mfma_f32_32x32x16_bf16 v[0:15], a[0:3], v[128:131], 0
  v_cvt_pk_bf16_f32 v120, v120, v121
  v_exp_f32 v124, v124
  v_exp_f32 v125, v125
  v_add_f32 v234, v234, v122
  v_mfma_f32_32x32x16_bf16 v[0:15], a[4:7], v[132:135], v[0:15]
  v_add_f32 v234, v234, v123
  v_cvt_pk_bf16_f32 v121, v122, v123
  v_exp_f32 v126, v126
  v_exp_f32 v127, v127
  v_mfma_f32_32x32x16_bf16 v[0:15], a[8:11], v[136:139], v[0:15]
  v_add_f32 v234, v234, v124
  v_add_f32 v234, v234, v125
  v_cvt_pk_bf16_f32 v122, v124, v125
  v_add_f32 v234, v234, v126
  v_add_f32 v234, v234, v127
  v_mfma_f32_32x32x16_bf16 v[0:15], a[12:15], v[140:143], v[0:15]
  v_mov_b32 v235, v234
  v_cvt_pk_bf16_f32 v123, v126, v127
  s_add_u32 m0, s24, 16384
  v_permlane32_swap_b32 v235, v234
  v_add_f32 v234, v234, v235
  v_mfma_f32_32x32x16_bf16 v[0:15], a[16:19], v[144:147], v[0:15]
  ds_write_b128 v224, v[120:123] offset:39936
  v_mul_f32 v192, v192, v240
  v_mfma_f32_32x32x16_bf16 v[0:15], a[20:23], v[148:151], v[0:15]
  ds_write_b32 v228, v234 offset:512
  v_mul_f32 v193, v193, v240
  v_cvt_pk_bf16_f32 v208, v192, v193
  v_mul_f32 v194, v194, v240
  v_mul_f32 v195, v195, v240
  v_mfma_f32_32x32x16_bf16 v[0:15], a[24:27], v[152:155], v[0:15]
  v_cvt_pk_bf16_f32 v209, v194, v195
  v_mul_f32 v196, v196, v240
  v_mul_f32 v197, v197, v240
  v_cvt_pk_bf16_f32 v210, v196, v197
  v_mul_f32 v198, v198, v240
  v_mfma_f32_32x32x16_bf16 v[0:15], a[28:31], v[156:159], v[0:15]
  v_mul_f32 v199, v199, v240
  v_cvt_pk_bf16_f32 v211, v198, v199
  v_mul_f32 v200, v200, v240
  v_mul_f32 v201, v201, v240
  v_cvt_pk_bf16_f32 v212, v200, v201
  v_mfma_f32_32x32x16_bf16 v[16:31], a[32:35], v[128:131], 0
  ds_write_b128 v244, v[208:211] offset:0
  v_mul_f32 v202, v202, v240
  v_mfma_f32_32x32x16_bf16 v[16:31], a[36:39], v[132:135], v[16:31]
  v_mul_f32 v203, v203, v240
  v_cvt_pk_bf16_f32 v213, v202, v203
  v_mul_f32 v204, v204, v240
  v_mul_f32 v205, v205, v240
  v_cvt_pk_bf16_f32 v214, v204, v205
  v_mfma_f32_32x32x16_bf16 v[16:31], a[40:43], v[136:139], v[16:31]
  v_mul_f32 v206, v206, v240
  v_exp_f32 v0, v0
  v_mul_f32 v207, v207, v240
  v_exp_f32 v1, v1
  v_mfma_f32_32x32x16_bf16 v[16:31], a[44:47], v[140:143], v[16:31]
  v_cvt_pk_bf16_f32 v215, v206, v207
  v_exp_f32 v2, v2
  v_exp_f32 v3, v3
  v_add_f32 v233, v0, v1
  v_mfma_f32_32x32x16_bf16 v[16:31], a[48:51], v[144:147], v[16:31]
  ds_write_b128 v245, v[212:215] offset:0
  v_cvt_pk_bf16_f32 v0, v0, v1
  v_mfma_f32_32x32x16_bf16 v[16:31], a[52:55], v[148:151], v[16:31]
  v_exp_f32 v4, v4
  v_exp_f32 v5, v5
  v_add_f32 v233, v233, v2
  v_add_f32 v233, v233, v3
  v_mfma_f32_32x32x16_bf16 v[16:31], a[56:59], v[152:155], v[16:31]
  v_cvt_pk_bf16_f32 v1, v2, v3
  v_exp_f32 v6, v6
  v_exp_f32 v7, v7
  v_add_f32 v233, v233, v4
  v_mfma_f32_32x32x16_bf16 v[16:31], a[60:63], v[156:159], v[16:31]
  s_waitcnt lgkmcnt(0)
  s_barrier
  v_add_f32 v233, v233, v5
  v_mfma_f32_32x32x16_bf16 v[32:47], a[64:67], v[128:131], 0
  ds_read_b128 v[236:239], v229 offset:512
  v_cvt_pk_bf16_f32 v2, v4, v5
  v_mfma_f32_32x32x16_bf16 v[32:47], a[68:71], v[132:135], v[32:47]
  ds_read_b128 v[208:211], v246 offset:0
  v_exp_f32 v8, v8
  v_mfma_f32_32x32x16_bf16 v[32:47], a[72:75], v[136:139], v[32:47]
  ds_read_b128 v[212:215], v247 offset:0
  v_exp_f32 v9, v9
  v_add_f32 v233, v233, v6
  v_add_f32 v233, v233, v7
  v_cvt_pk_bf16_f32 v3, v6, v7
  v_mfma_f32_32x32x16_bf16 v[32:47], a[76:79], v[140:143], v[32:47]
  v_exp_f32 v10, v10
  v_exp_f32 v11, v11
  v_mfma_f32_32x32x16_bf16 v[32:47], a[80:83], v[144:147], v[32:47]
  s_waitcnt lgkmcnt(1)
  buffer_store_dwordx4 v[208:211], v248, s[16:19], s22 offen sc1
  v_mfma_f32_32x32x16_bf16 v[32:47], a[84:87], v[148:151], v[32:47]
  ds_write_b128 v224, v[0:3] offset:0
  v_add_f32 v233, v233, v8
  v_mfma_f32_32x32x16_bf16 v[32:47], a[88:91], v[152:155], v[32:47]
  s_waitcnt lgkmcnt(1)
  buffer_store_dwordx4 v[212:215], v248, s[16:19], s22 offen offset:1024 sc1
  v_mfma_f32_32x32x16_bf16 v[32:47], a[92:95], v[156:159], v[32:47]
  v_add_f32 v233, v233, v9
  v_cvt_pk_bf16_f32 v8, v8, v9
  v_exp_f32 v12, v12
  v_exp_f32 v13, v13
  v_mfma_f32_32x32x16_bf16 v[48:63], a[96:99], v[128:131], 0
  v_add_f32 v233, v233, v10
  v_add_f32 v233, v233, v11
  v_cvt_pk_bf16_f32 v9, v10, v11
  v_exp_f32 v14, v14
  v_mfma_f32_32x32x16_bf16 v[48:63], a[100:103], v[132:135], v[48:63]
  v_exp_f32 v15, v15
  v_add_f32 v233, v233, v12
  v_add_f32 v233, v233, v13
  v_cvt_pk_bf16_f32 v10, v12, v13
  v_mfma_f32_32x32x16_bf16 v[48:63], a[104:107], v[136:139], v[48:63]
  v_exp_f32 v16, v16
  v_exp_f32 v17, v17
  v_add_f32 v233, v233, v14
  v_mfma_f32_32x32x16_bf16 v[48:63], a[108:111], v[140:143], v[48:63]
  v_add_f32 v233, v233, v15
  v_cvt_pk_bf16_f32 v11, v14, v15
  v_exp_f32 v18, v18
  v_add_f32 v242, v236, v237
  v_mfma_f32_32x32x16_bf16 v[48:63], a[112:115], v[144:147], v[48:63]
  ds_write_b128 v224, v[8:11] offset:1024
  v_mfma_f32_32x32x16_bf16 v[48:63], a[116:119], v[148:151], v[48:63]
  v_exp_f32 v19, v19
  v_add_f32 v233, v233, v16
  v_add_f32 v233, v233, v17
  v_cvt_pk_bf16_f32 v16, v16, v17
  v_mfma_f32_32x32x16_bf16 v[48:63], a[120:123], v[152:155], v[48:63]
  v_exp_f32 v20, v20
  v_exp_f32 v21, v21
  v_add_f32 v233, v233, v18
  v_mfma_f32_32x32x16_bf16 v[48:63], a[124:127], v[156:159], v[48:63]
  v_add_f32 v233, v233, v19
  v_cvt_pk_bf16_f32 v17, v18, v19
  v_exp_f32 v22, v22
  v_add_f32 v238, v238, v239
  v_mfma_f32_32x32x16_bf16 v[192:207], a[128:131], v[64:67], 0
  ds_read_b128 v[160:163], v225 offset:32768
  v_exp_f32 v23, v23
  v_add_f32 v233, v233, v20
  v_add_f32 v233, v233, v21
  v_cvt_pk_bf16_f32 v18, v20, v21
  v_mfma_f32_32x32x16_bf16 v[192:207], a[132:135], v[72:75], v[192:207]
  ds_read_b128 v[164:167], v225 offset:33792
  v_exp_f32 v24, v24
  v_exp_f32 v25, v25
  v_add_f32 v233, v233, v22
  v_mfma_f32_32x32x16_bf16 v[192:207], a[136:139], v[80:83], v[192:207]
  ds_read_b128 v[168:171], v225 offset:34816
  v_add_f32 v233, v233, v23
  v_cvt_pk_bf16_f32 v19, v22, v23
  v_exp_f32 v26, v26
  v_add_f32 v242, v242, v238
  v_mfma_f32_32x32x16_bf16 v[192:207], a[140:143], v[88:91], v[192:207]
  ds_read_b128 v[172:175], v225 offset:35840
  ds_write_b128 v224, v[16:19] offset:2048
  v_mfma_f32_32x32x16_bf16 v[192:207], a[144:147], v[96:99], v[192:207]
  ds_read_b128 v[176:179], v225 offset:36864
  v_exp_f32 v27, v27
  v_add_f32 v233, v233, v24
  v_add_f32 v233, v233, v25
  v_cvt_pk_bf16_f32 v24, v24, v25
  v_mfma_f32_32x32x16_bf16 v[192:207], a[148:151], v[104:107], v[192:207]
  ds_read_b128 v[180:183], v225 offset:37888
  v_exp_f32 v28, v28
  v_exp_f32 v29, v29
  v_add_f32 v233, v233, v26
  v_mfma_f32_32x32x16_bf16 v[192:207], a[152:155], v[112:115], v[192:207]
  ds_read_b128 v[184:187], v225 offset:38912
  v_add_f32 v233, v233, v27
  v_cvt_pk_bf16_f32 v25, v26, v27
  v_exp_f32 v30, v30
  v_mfma_f32_32x32x16_bf16 v[192:207], a[156:159], v[120:123], v[192:207]
  ds_read_b128 v[188:191], v225 offset:39936
  v_exp_f32 v31, v31
  v_add_f32 v233, v233, v28
  v_add_f32 v233, v233, v29
  s_waitcnt lgkmcnt(5)
  v_mfma_f32_32x32x16_bf16 v[192:207], a[160:163], v[160:163], v[192:207]
  ds_read_b128 v[160:163], v226 offset:32768
  v_cvt_pk_bf16_f32 v26, v28, v29
  v_rcp_f32 v241, v242
  v_exp_f32 v32, v32
  v_mfma_f32_32x32x16_bf16 v[192:207], a[164:167], v[164:167], v[192:207]
  ds_read_b128 v[164:167], v226 offset:33792
  v_exp_f32 v33, v33
  v_add_f32 v233, v233, v30
  v_add_f32 v233, v233, v31
  v_cvt_pk_bf16_f32 v27, v30, v31
  v_mfma_f32_32x32x16_bf16 v[192:207], a[168:171], v[168:171], v[192:207]
  ds_read_b128 v[168:171], v226 offset:34816
  ds_write_b128 v224, v[24:27] offset:3072
  v_mfma_f32_32x32x16_bf16 v[192:207], a[172:175], v[172:175], v[192:207]
  ds_read_b128 v[172:175], v226 offset:35840
  v_exp_f32 v34, v34
  v_exp_f32 v35, v35
  s_waitcnt lgkmcnt(5)
  v_mfma_f32_32x32x16_bf16 v[192:207], a[176:179], v[176:179], v[192:207]
  ds_read_b128 v[176:179], v226 offset:36864
  v_add_f32 v233, v233, v32
  v_add_f32 v233, v233, v33
  v_cvt_pk_bf16_f32 v32, v32, v33
  v_exp_f32 v36, v36
  v_mfma_f32_32x32x16_bf16 v[192:207], a[180:183], v[180:183], v[192:207]
  ds_read_b128 v[180:183], v226 offset:37888
  v_exp_f32 v37, v37
  v_add_f32 v233, v233, v34
  v_add_f32 v233, v233, v35
  v_cvt_pk_bf16_f32 v33, v34, v35
  v_mfma_f32_32x32x16_bf16 v[192:207], a[184:187], v[184:187], v[192:207]
  ds_read_b128 v[184:187], v226 offset:38912
  v_exp_f32 v38, v38
  v_exp_f32 v39, v39
  v_add_f32 v233, v233, v36
  v_mfma_f32_32x32x16_bf16 v[192:207], a[188:191], v[188:191], v[192:207]
  ds_read_b128 v[188:191], v226 offset:39936
  v_add_f32 v233, v233, v37
  v_cvt_pk_bf16_f32 v34, v36, v37
  v_exp_f32 v40, v40
  s_waitcnt lgkmcnt(4)
  v_mfma_f32_32x32x16_bf16 v[192:207], a[192:195], v[160:163], v[192:207]
  ds_read_b128 v[160:163], v227 offset:32768
  v_exp_f32 v41, v41
  v_add_f32 v233, v233, v38
  v_add_f32 v233, v233, v39
  v_cvt_pk_bf16_f32 v35, v38, v39
  v_mfma_f32_32x32x16_bf16 v[192:207], a[196:199], v[164:167], v[192:207]
  ds_read_b128 v[164:167], v227 offset:33792
  ds_write_b128 v224, v[32:35] offset:4096
  v_mfma_f32_32x32x16_bf16 v[192:207], a[200:203], v[168:171], v[192:207]
  ds_read_b128 v[168:171], v227 offset:34816
  v_exp_f32 v42, v42
  v_exp_f32 v43, v43
  v_add_f32 v233, v233, v40
  v_mfma_f32_32x32x16_bf16 v[192:207], a[204:207], v[172:175], v[192:207]
  ds_read_b128 v[172:175], v227 offset:35840
  v_add_f32 v233, v233, v41
  v_cvt_pk_bf16_f32 v40, v40, v41
  v_exp_f32 v44, v44
  s_waitcnt lgkmcnt(5)
  v_mfma_f32_32x32x16_bf16 v[192:207], a[208:211], v[176:179], v[192:207]
  ds_read_b128 v[176:179], v227 offset:36864
  v_exp_f32 v45, v45
  v_add_f32 v233, v233, v42
  v_add_f32 v233, v233, v43
  v_cvt_pk_bf16_f32 v41, v42, v43
  v_mfma_f32_32x32x16_bf16 v[192:207], a[212:215], v[180:183], v[192:207]
  ds_read_b128 v[180:183], v227 offset:37888
  v_exp_f32 v46, v46
  v_exp_f32 v47, v47
  v_add_f32 v233, v233, v44
  v_mfma_f32_32x32x16_bf16 v[192:207], a[216:219], v[184:187], v[192:207]
  ds_read_b128 v[184:187], v227 offset:38912
  v_add_f32 v233, v233, v45
  v_cvt_pk_bf16_f32 v42, v44, v45
  v_exp_f32 v48, v48
  v_maximum3_f32 v243, v243, v242, v241
  v_mfma_f32_32x32x16_bf16 v[192:207], a[220:223], v[188:191], v[192:207]
  ds_read_b128 v[188:191], v227 offset:39936
  v_exp_f32 v49, v49
  v_add_f32 v233, v233, v46
  v_add_f32 v233, v233, v47
  s_waitcnt lgkmcnt(4)
  v_mfma_f32_32x32x16_bf16 v[192:207], a[224:227], v[160:163], v[192:207]
  v_cvt_pk_bf16_f32 v43, v46, v47
  v_exp_f32 v50, v50
  v_exp_f32 v51, v51
  v_add_f32 v233, v233, v48
  v_mfma_f32_32x32x16_bf16 v[192:207], a[228:231], v[164:167], v[192:207]
  ds_write_b128 v224, v[40:43] offset:5120
  v_add_f32 v233, v233, v49
  v_mfma_f32_32x32x16_bf16 v[192:207], a[232:235], v[168:171], v[192:207]
  v_cvt_pk_bf16_f32 v48, v48, v49
  v_exp_f32 v52, v52
  v_exp_f32 v53, v53
  v_add_f32 v233, v233, v50
  v_mfma_f32_32x32x16_bf16 v[192:207], a[236:239], v[172:175], v[192:207]
  v_add_f32 v233, v233, v51
  v_cvt_pk_bf16_f32 v49, v50, v51
  v_exp_f32 v54, v54
  s_add_u32 s22, s22, 8192
  s_waitcnt lgkmcnt(1)
  v_mfma_f32_32x32x16_bf16 v[192:207], a[240:243], v[176:179], v[192:207]
  v_exp_f32 v55, v55
  v_add_f32 v233, v233, v52
  v_add_f32 v233, v233, v53
  v_cvt_pk_bf16_f32 v50, v52, v53
  v_mfma_f32_32x32x16_bf16 v[192:207], a[244:247], v[180:183], v[192:207]
  v_exp_f32 v56, v56
  v_exp_f32 v57, v57
  v_add_f32 v233, v233, v54
  v_add_f32 v233, v233, v55
  v_mfma_f32_32x32x16_bf16 v[192:207], a[248:251], v[184:187], v[192:207]
  v_cvt_pk_bf16_f32 v51, v54, v55
  v_exp_f32 v58, v58
  v_exp_f32 v59, v59
  v_add_f32 v233, v233, v56
  v_mfma_f32_32x32x16_bf16 v[192:207], a[252:255], v[188:191], v[192:207]
  ds_write_b128 v224, v[48:51] offset:6144
  v_add_f32 v233, v233, v57
  v_cvt_pk_bf16_f32 v56, v56, v57
  v_exp_f32 v60, v60
  v_exp_f32 v61, v61
  v_add_f32 v233, v233, v58
  v_add_f32 v233, v233, v59
  v_cvt_pk_bf16_f32 v57, v58, v59
  v_exp_f32 v62, v62
  v_exp_f32 v63, v63
  v_add_f32 v233, v233, v60
  v_add_f32 v233, v233, v61
  v_cvt_pk_bf16_f32 v58, v60, v61
  v_add_f32 v233, v233, v62
  v_add_f32 v233, v233, v63
  v_mov_b32 v235, v233
  v_cvt_pk_bf16_f32 v59, v62, v63
  s_add_u32 m0, s24, 24576
  v_permlane32_swap_b32 v235, v233
  v_add_f32 v233, v233, v235
  ds_write_b128 v224, v[56:59] offset:7168
  v_mul_f32 v192, v192, v241
  ds_write_b32 v228, v233 offset:0
  v_mul_f32 v193, v193, v241
  v_cvt_pk_bf16_f32 v208, v192, v193
  v_mul_f32 v194, v194, v241
  v_mul_f32 v195, v195, v241
  v_cvt_pk_bf16_f32 v209, v194, v195
  v_mul_f32 v196, v196, v241
  v_mul_f32 v197, v197, v241
  v_cvt_pk_bf16_f32 v210, v196, v197
  v_mul_f32 v198, v198, v241
  v_mul_f32 v199, v199, v241
  v_cvt_pk_bf16_f32 v211, v198, v199
  v_mul_f32 v200, v200, v241
  v_mul_f32 v201, v201, v241
  v_cvt_pk_bf16_f32 v212, v200, v201
  ds_write_b128 v244, v[208:211] offset:8192
  v_mul_f32 v202, v202, v241
  v_mul_f32 v203, v203, v241
  v_cvt_pk_bf16_f32 v213, v202, v203
  v_mul_f32 v204, v204, v241
  v_mul_f32 v205, v205, v241
  v_cvt_pk_bf16_f32 v214, v204, v205
  v_mul_f32 v206, v206, v241
  v_mul_f32 v207, v207, v241
  v_cvt_pk_bf16_f32 v215, v206, v207
  ds_write_b128 v245, v[212:215] offset:8192
  s_waitcnt vmcnt(8) lgkmcnt(0)
  s_barrier
  ds_read_b128 v[236:239], v229 offset:0
  ds_read_b128 v[208:211], v246 offset:8192
  ds_read_b128 v[212:215], v247 offset:8192
  s_waitcnt lgkmcnt(1)
  buffer_store_dwordx4 v[208:211], v248, s[16:19], s22 offen sc1
  s_waitcnt lgkmcnt(0)
  buffer_store_dwordx4 v[212:215], v248, s[16:19], s22 offen offset:1024 sc1
  v_add_f32 v242, v236, v237
  v_add_f32 v238, v238, v239
  v_mfma_f32_32x32x16_bf16 v[192:207], a[128:131], v[0:3], 0
  ds_read_b128 v[160:163], v225 offset:0
  v_mfma_f32_32x32x16_bf16 v[192:207], a[132:135], v[8:11], v[192:207]
  ds_read_b128 v[164:167], v225 offset:1024
  v_mfma_f32_32x32x16_bf16 v[192:207], a[136:139], v[16:19], v[192:207]
  ds_read_b128 v[168:171], v225 offset:2048
  v_add_f32 v242, v242, v238
  v_mfma_f32_32x32x16_bf16 v[192:207], a[140:143], v[24:27], v[192:207]
  ds_read_b128 v[172:175], v225 offset:3072
  v_mfma_f32_32x32x16_bf16 v[192:207], a[144:147], v[32:35], v[192:207]
  ds_read_b128 v[176:179], v225 offset:4096
  v_mfma_f32_32x32x16_bf16 v[192:207], a[148:151], v[40:43], v[192:207]
  ds_read_b128 v[180:183], v225 offset:5120
  v_mfma_f32_32x32x16_bf16 v[192:207], a[152:155], v[48:51], v[192:207]
  ds_read_b128 v[184:187], v225 offset:6144
  v_mfma_f32_32x32x16_bf16 v[192:207], a[156:159], v[56:59], v[192:207]
  ds_read_b128 v[188:191], v225 offset:7168
  s_waitcnt lgkmcnt(4)
  v_mfma_f32_32x32x16_bf16 v[192:207], a[160:163], v[160:163], v[192:207]
  ds_read_b128 v[160:163], v226 offset:0
  v_rcp_f32 v240, v242
  v_mfma_f32_32x32x16_bf16 v[192:207], a[164:167], v[164:167], v[192:207]
  ds_read_b128 v[164:167], v226 offset:1024
  v_mfma_f32_32x32x16_bf16 v[192:207], a[168:171], v[168:171], v[192:207]
  ds_read_b128 v[168:171], v226 offset:2048
  v_mfma_f32_32x32x16_bf16 v[192:207], a[172:175], v[172:175], v[192:207]
  ds_read_b128 v[172:175], v226 offset:3072
  s_waitcnt lgkmcnt(4)
  v_mfma_f32_32x32x16_bf16 v[192:207], a[176:179], v[176:179], v[192:207]
  ds_read_b128 v[176:179], v226 offset:4096
  v_mfma_f32_32x32x16_bf16 v[192:207], a[180:183], v[180:183], v[192:207]
  ds_read_b128 v[180:183], v226 offset:5120
  v_mfma_f32_32x32x16_bf16 v[192:207], a[184:187], v[184:187], v[192:207]
  ds_read_b128 v[184:187], v226 offset:6144
  v_mfma_f32_32x32x16_bf16 v[192:207], a[188:191], v[188:191], v[192:207]
  ds_read_b128 v[188:191], v226 offset:7168
  s_waitcnt lgkmcnt(4)
  v_mfma_f32_32x32x16_bf16 v[192:207], a[192:195], v[160:163], v[192:207]
  ds_read_b128 v[160:163], v227 offset:0
  v_mfma_f32_32x32x16_bf16 v[192:207], a[196:199], v[164:167], v[192:207]
  ds_read_b128 v[164:167], v227 offset:1024
  v_mfma_f32_32x32x16_bf16 v[192:207], a[200:203], v[168:171], v[192:207]
  ds_read_b128 v[168:171], v227 offset:2048
  v_mfma_f32_32x32x16_bf16 v[192:207], a[204:207], v[172:175], v[192:207]
  ds_read_b128 v[172:175], v227 offset:3072
  s_waitcnt lgkmcnt(4)
  v_mfma_f32_32x32x16_bf16 v[192:207], a[208:211], v[176:179], v[192:207]
  ds_read_b128 v[176:179], v227 offset:4096
  v_mfma_f32_32x32x16_bf16 v[192:207], a[212:215], v[180:183], v[192:207]
  ds_read_b128 v[180:183], v227 offset:5120
  v_mfma_f32_32x32x16_bf16 v[192:207], a[216:219], v[184:187], v[192:207]
  ds_read_b128 v[184:187], v227 offset:6144
  v_maximum3_f32 v243, v243, v242, v240
  v_mfma_f32_32x32x16_bf16 v[192:207], a[220:223], v[188:191], v[192:207]
  ds_read_b128 v[188:191], v227 offset:7168
  s_waitcnt lgkmcnt(4)
  v_mfma_f32_32x32x16_bf16 v[192:207], a[224:227], v[160:163], v[192:207]
  v_mfma_f32_32x32x16_bf16 v[192:207], a[228:231], v[164:167], v[192:207]
  v_mfma_f32_32x32x16_bf16 v[192:207], a[232:235], v[168:171], v[192:207]
  v_mfma_f32_32x32x16_bf16 v[192:207], a[236:239], v[172:175], v[192:207]
  s_add_u32 s22, s22, 8192
  s_waitcnt lgkmcnt(0)
  v_mfma_f32_32x32x16_bf16 v[192:207], a[240:243], v[176:179], v[192:207]
  v_mfma_f32_32x32x16_bf16 v[192:207], a[244:247], v[180:183], v[192:207]
  v_mfma_f32_32x32x16_bf16 v[192:207], a[248:251], v[184:187], v[192:207]
  v_mfma_f32_32x32x16_bf16 v[192:207], a[252:255], v[188:191], v[192:207]
  s_add_u32 m0, s24, 0
  s_nop 10
  v_mul_f32 v192, v192, v240
  v_mul_f32 v193, v193, v240
  v_cvt_pk_bf16_f32 v208, v192, v193
  v_mul_f32 v194, v194, v240
  v_mul_f32 v195, v195, v240
  v_cvt_pk_bf16_f32 v209, v194, v195
  v_mul_f32 v196, v196, v240
  v_mul_f32 v197, v197, v240
  v_cvt_pk_bf16_f32 v210, v196, v197
  v_mul_f32 v198, v198, v240
  v_mul_f32 v199, v199, v240
  v_cvt_pk_bf16_f32 v211, v198, v199
  v_mul_f32 v200, v200, v240
  v_mul_f32 v201, v201, v240
  v_cvt_pk_bf16_f32 v212, v200, v201
  ds_write_b128 v244, v[208:211] offset:0
  v_mul_f32 v202, v202, v240
  v_mul_f32 v203, v203, v240
  v_cvt_pk_bf16_f32 v213, v202, v203
  v_mul_f32 v204, v204, v240
  v_mul_f32 v205, v205, v240
  v_cvt_pk_bf16_f32 v214, v204, v205
  v_mul_f32 v206, v206, v240
  v_mul_f32 v207, v207, v240
  v_cvt_pk_bf16_f32 v215, v206, v207
  ds_write_b128 v245, v[212:215] offset:0
  s_waitcnt vmcnt(6) lgkmcnt(0)
  s_barrier
  ds_read_b128 v[208:211], v246 offset:0
  ds_read_b128 v[212:215], v247 offset:0
  s_waitcnt lgkmcnt(1)
  buffer_store_dwordx4 v[208:211], v248, s[16:19], s22 offen sc1
  s_waitcnt lgkmcnt(0)
  buffer_store_dwordx4 v[212:215], v248, s[16:19], s22 offen offset:1024 sc1
  s_add_u32 s22, s22, 8192
  v_mfma_f32_16x16x32_bf16 v[252:255], a[128:131], a[128:131], 0
  v_mfma_f32_16x16x32_bf16 v[252:255], a[132:135], a[132:135], v[252:255]
  v_mfma_f32_16x16x32_bf16 v[252:255], a[136:139], a[136:139], v[252:255]
  v_mfma_f32_16x16x32_bf16 v[252:255], a[140:143], a[140:143], v[252:255]
  v_mfma_f32_16x16x32_bf16 v[252:255], a[144:147], a[144:147], v[252:255]
  v_mfma_f32_16x16x32_bf16 v[252:255], a[148:151], a[148:151], v[252:255]
  v_mfma_f32_16x16x32_bf16 v[252:255], a[152:155], a[152:155], v[252:255]
  v_mfma_f32_16x16x32_bf16 v[252:255], a[156:159], a[156:159], v[252:255]
  v_mfma_f32_16x16x32_bf16 v[252:255], a[160:163], a[160:163], v[252:255]
  v_mfma_f32_16x16x32_bf16 v[252:255], a[164:167], a[164:167], v[252:255]
  v_mfma_f32_16x16x32_bf16 v[252:255], a[168:171], a[168:171], v[252:255]
  v_mfma_f32_16x16x32_bf16 v[252:255], a[172:175], a[172:175], v[252:255]
  v_mfma_f32_16x16x32_bf16 v[252:255], a[176:179], a[176:179], v[252:255]
  v_mfma_f32_16x16x32_bf16 v[252:255], a[180:183], a[180:183], v[252:255]
  v_mfma_f32_16x16x32_bf16 v[252:255], a[184:187], a[184:187], v[252:255]
  v_mfma_f32_16x16x32_bf16 v[252:255], a[188:191], a[188:191], v[252:255]
  v_mfma_f32_16x16x32_bf16 v[252:255], a[192:195], a[192:195], v[252:255]
  v_mfma_f32_16x16x32_bf16 v[252:255], a[196:199], a[196:199], v[252:255]
  v_mfma_f32_16x16x32_bf16 v[252:255], a[200:203], a[200:203], v[252:255]
  v_mfma_f32_16x16x32_bf16 v[252:255], a[204:207], a[204:207], v[252:255]
  v_mfma_f32_16x16x32_bf16 v[252:255], a[208:211], a[208:211], v[252:255]
  v_mfma_f32_16x16x32_bf16 v[252:255], a[212:215], a[212:215], v[252:255]
  v_mfma_f32_16x16x32_bf16 v[252:255], a[216:219], a[216:219], v[252:255]
  v_mfma_f32_16x16x32_bf16 v[252:255], a[220:223], a[220:223], v[252:255]
  v_mfma_f32_16x16x32_bf16 v[252:255], a[224:227], a[224:227], v[252:255]
  v_mfma_f32_16x16x32_bf16 v[252:255], a[228:231], a[228:231], v[252:255]
  v_mfma_f32_16x16x32_bf16 v[252:255], a[232:235], a[232:235], v[252:255]
  v_mfma_f32_16x16x32_bf16 v[252:255], a[236:239], a[236:239], v[252:255]
  v_mfma_f32_16x16x32_bf16 v[252:255], a[240:243], a[240:243], v[252:255]
  v_mfma_f32_16x16x32_bf16 v[252:255], a[244:247], a[244:247], v[252:255]
  v_mfma_f32_16x16x32_bf16 v[252:255], a[248:251], a[248:251], v[252:255]
  v_mfma_f32_16x16x32_bf16 v[252:255], a[252:255], a[252:255], v[252:255]
  s_nop 7
  v_maximum3_f32 v252, |v252|, |v253|, |v254|
  v_maximum3_f32 v252, v252, |v255|, |v255|
  v_cmp_nle_f32_e64 s[28:29], v252, s35
  v_cmp_nle_f32_e64 s[30:31], v243, v249
  s_lshl_b32 s48, s20, 2
  s_add_u32 s48, s48, 99840
  s_or_b64 s[28:29], s[28:29], s[30:31]
  s_or_b32 s28, s28, s29
  v_mov_b32 v253, s48
  v_mov_b32 v254, s28
  ds_write_b32 v253, v254 offset:0
  v_mov_b32 v253, 99840
  s_waitcnt lgkmcnt(0)
  s_barrier
  ds_read_b128 v[252:255], v253 offset:0
  s_waitcnt lgkmcnt(0)
  v_or3_b32 v252, v252, v253, v254
  v_or_b32 v252, v252, v255
  v_cmp_ne_u32_e32 vcc, 0, v252
  s_nop 4
  s_cbranch_vccz L_done
  s_waitcnt vmcnt(0) lgkmcnt(0)
  s_barrier
  s_mov_b32 s21, 0
  s_mov_b32 s23, 31
  v_add_u32 v250, 1024, v228
  v_add_u32 v251, 1024, v229
L_slow:
  s_mov_b32 m0, s24
  s_nop 0
  buffer_load_dwordx4 v231, s[4:7], s21 offen nt lds
  buffer_load_dwordx4 v232, s[4:7], s21 offen offset:1024 nt lds
  s_waitcnt vmcnt(0) lgkmcnt(0)
  s_barrier
  ds_read_b128 v[128:131], v216 offset:0
  ds_read_b128 v[132:135], v217 offset:0
  ds_read_b128 v[136:139], v218 offset:0
  ds_read_b128 v[140:143], v219 offset:0
  ds_read_b128 v[144:147], v220 offset:0
  ds_read_b128 v[148:151], v221 offset:0
  ds_read_b128 v[152:155], v222 offset:0
  ds_read_b128 v[156:159], v223 offset:0
  s_waitcnt lgkmcnt(7)
  v_mfma_f32_32x32x16_bf16 v[0:15], a[0:3], v[128:131], 0
  s_waitcnt lgkmcnt(6)
  v_mfma_f32_32x32x16_bf16 v[0:15], a[4:7], v[132:135], v[0:15]
  s_waitcnt lgkmcnt(5)
  v_mfma_f32_32x32x16_bf16 v[0:15], a[8:11], v[136:139], v[0:15]
  s_waitcnt lgkmcnt(4)
  v_mfma_f32_32x32x16_bf16 v[0:15], a[12:15], v[140:143], v[0:15]
  s_waitcnt lgkmcnt(3)
  v_mfma_f32_32x32x16_bf16 v[0:15], a[16:19], v[144:147], v[0:15]
  s_waitcnt lgkmcnt(2)
  v_mfma_f32_32x32x16_bf16 v[0:15], a[20:23], v[148:151], v[0:15]
  s_waitcnt lgkmcnt(1)
  v_mfma_f32_32x32x16_bf16 v[0:15], a[24:27], v[152:155], v[0:15]
  s_waitcnt lgkmcnt(0)
  v_mfma_f32_32x32x16_bf16 v[0:15], a[28:31], v[156:159], v[0:15]
  v_mfma_f32_32x32x16_bf16 v[16:31], a[32:35], v[128:131], 0
  v_mfma_f32_32x32x16_bf16 v[16:31], a[36:39], v[132:135], v[16:31]
  v_mfma_f32_32x32x16_bf16 v[16:31], a[40:43], v[136:139], v[16:31]
  v_mfma_f32_32x32x16_bf16 v[16:31], a[44:47], v[140:143], v[16:31]
  v_mfma_f32_32x32x16_bf16 v[16:31], a[48:51], v[144:147], v[16:31]
  v_mfma_f32_32x32x16_bf16 v[16:31], a[52:55], v[148:151], v[16:31]
  v_mfma_f32_32x32x16_bf16 v[16:31], a[56:59], v[152:155], v[16:31]
  v_mfma_f32_32x32x16_bf16 v[16:31], a[60:63], v[156:159], v[16:31]
  v_mfma_f32_32x32x16_bf16 v[32:47], a[64:67], v[128:131], 0
  v_mfma_f32_32x32x16_bf16 v[32:47], a[68:71], v[132:135], v[32:47]
  v_mfma_f32_32x32x16_bf16 v[32:47], a[72:75], v[136:139], v[32:47]
  v_mfma_f32_32x32x16_bf16 v[32:47], a[76:79], v[140:143], v[32:47]
  v_mfma_f32_32x32x16_bf16 v[32:47], a[80:83], v[144:147], v[32:47]
  v_mfma_f32_32x32x16_bf16 v[32:47], a[84:87], v[148:151], v[32:47]
  v_mfma_f32_32x32x16_bf16 v[32:47], a[88:91], v[152:155], v[32:47]
  v_mfma_f32_32x32x16_bf16 v[32:47], a[92:95], v[156:159], v[32:47]
  v_mfma_f32_32x32x16_bf16 v[48:63], a[96:99], v[128:131], 0
  v_mfma_f32_32x32x16_bf16 v[48:63], a[100:103], v[132:135], v[48:63]
  v_mfma_f32_32x32x16_bf16 v[48:63], a[104:107], v[136:139], v[48:63]
  v_mfma_f32_32x32x16_bf16 v[48:63], a[108:111], v[140:143], v[48:63]
  v_mfma_f32_32x32x16_bf16 v[48:63], a[112:115], v[144:147], v[48:63]
  v_mfma_f32_32x32x16_bf16 v[48:63], a[116:119], v[148:151], v[48:63]
  v_mfma_f32_32x32x16_bf16 v[48:63], a[120:123], v[152:155], v[48:63]
  v_mfma_f32_32x32x16_bf16 v[48:63], a[124:127], v[156:159], v[48:63]
  v_max3_f32 v252, v0, v1, v2
  v_max3_f32 v252, v3, v4, v252
  v_max3_f32 v252, v5, v6, v252
  v_max3_f32 v252, v7, v8, v252
  v_max3_f32 v252, v9, v10, v252
  v_max3_f32 v252, v11, v12, v252
  v_max3_f32 v252, v13, v14, v252
  v_max3_f32 v252, v15, v16, v252
  v_max3_f32 v252, v17, v18, v252
  v_max3_f32 v252, v19, v20, v252
  v_max3_f32 v252, v21, v22, v252
  v_max3_f32 v252, v23, v24, v252
  v_max3_f32 v252, v25, v26, v252
  v_max3_f32 v252, v27, v28, v252
  v_max3_f32 v252, v29, v30, v252
  v_max3_f32 v252, v31, v32, v252
  v_max3_f32 v252, v33, v34, v252
  v_max3_f32 v252, v35, v36, v252
  v_max3_f32 v252, v37, v38, v252
  v_max3_f32 v252, v39, v40, v252
  v_max3_f32 v252, v41, v42, v252
  v_max3_f32 v252, v43, v44, v252
  v_max3_f32 v252, v45, v46, v252
  v_max3_f32 v252, v47, v48, v252
  v_max3_f32 v252, v49, v50, v252
  v_max3_f32 v252, v51, v52, v252
  v_max3_f32 v252, v53, v54, v252
  v_max3_f32 v252, v55, v56, v252
  v_max3_f32 v252, v57, v58, v252
  v_max3_f32 v252, v59, v60, v252
  v_max3_f32 v252, v61, v62, v252
  v_max_f32 v252, v63, v252
  v_mov_b32 v235, v252
  s_nop 1
  v_permlane32_swap_b32 v235, v252
  v_max_f32 v252, v252, v235
  ds_write_b32 v250, v252 offset:0
  s_waitcnt lgkmcnt(0)
  s_barrier
  ds_read_b128 v[236:239], v251 offset:0
  s_waitcnt lgkmcnt(0)
  v_max3_f32 v252, v236, v237, v238
  v_max_f32 v252, v252, v239
  v_sub_f32 v0, v0, v252
  v_exp_f32 v0, v0
  v_sub_f32 v1, v1, v252
  v_exp_f32 v1, v1
  v_sub_f32 v2, v2, v252
  v_exp_f32 v2, v2
  v_sub_f32 v3, v3, v252
  v_exp_f32 v3, v3
  v_sub_f32 v4, v4, v252
  v_exp_f32 v4, v4
  v_sub_f32 v5, v5, v252
  v_exp_f32 v5, v5
  v_sub_f32 v6, v6, v252
  v_exp_f32 v6, v6
  v_sub_f32 v7, v7, v252
  v_exp_f32 v7, v7
  v_sub_f32 v8, v8, v252
  v_exp_f32 v8, v8
  v_sub_f32 v9, v9, v252
  v_exp_f32 v9, v9
  v_sub_f32 v10, v10, v252
  v_exp_f32 v10, v10
  v_sub_f32 v11, v11, v252
  v_exp_f32 v11, v11
  v_sub_f32 v12, v12, v252
  v_exp_f32 v12, v12
  v_sub_f32 v13, v13, v252
  v_exp_f32 v13, v13
  v_sub_f32 v14, v14, v252
  v_exp_f32 v14, v14
  v_sub_f32 v15, v15, v252
  v_exp_f32 v15, v15
  v_sub_f32 v16, v16, v252
  v_exp_f32 v16, v16
  v_sub_f32 v17, v17, v252
  v_exp_f32 v17, v17
  v_sub_f32 v18, v18, v252
  v_exp_f32 v18, v18
  v_sub_f32 v19, v19, v252
  v_exp_f32 v19, v19
  v_sub_f32 v20, v20, v252
  v_exp_f32 v20, v20
  v_sub_f32 v21, v21, v252
  v_exp_f32 v21, v21
  v_sub_f32 v22, v22, v252
  v_exp_f32 v22, v22
  v_sub_f32 v23, v23, v252
  v_exp_f32 v23, v23
  v_sub_f32 v24, v24, v252
  v_exp_f32 v24, v24
  v_sub_f32 v25, v25, v252
  v_exp_f32 v25, v25
  v_sub_f32 v26, v26, v252
  v_exp_f32 v26, v26
  v_sub_f32 v27, v27, v252
  v_exp_f32 v27, v27
  v_sub_f32 v28, v28, v252
  v_exp_f32 v28, v28
  v_sub_f32 v29, v29, v252
  v_exp_f32 v29, v29
  v_sub_f32 v30, v30, v252
  v_exp_f32 v30, v30
  v_sub_f32 v31, v31, v252
  v_exp_f32 v31, v31
  v_sub_f32 v32, v32, v252
  v_exp_f32 v32, v32
  v_sub_f32 v33, v33, v252
  v_exp_f32 v33, v33
  v_sub_f32 v34, v34, v252
  v_exp_f32 v34, v34
  v_sub_f32 v35, v35, v252
  v_exp_f32 v35, v35
  v_sub_f32 v36, v36, v252
  v_exp_f32 v36, v36
  v_sub_f32 v37, v37, v252
  v_exp_f32 v37, v37
  v_sub_f32 v38, v38, v252
  v_exp_f32 v38, v38
  v_sub_f32 v39, v39, v252
  v_exp_f32 v39, v39
  v_sub_f32 v40, v40, v252
  v_exp_f32 v40, v40
  v_sub_f32 v41, v41, v252
  v_exp_f32 v41, v41
  v_sub_f32 v42, v42, v252
  v_exp_f32 v42, v42
  v_sub_f32 v43, v43, v252
  v_exp_f32 v43, v43
  v_sub_f32 v44, v44, v252
  v_exp_f32 v44, v44
  v_sub_f32 v45, v45, v252
  v_exp_f32 v45, v45
  v_sub_f32 v46, v46, v252
  v_exp_f32 v46, v46
  v_sub_f32 v47, v47, v252
  v_exp_f32 v47, v47
  v_sub_f32 v48, v48, v252
  v_exp_f32 v48, v48
  v_sub_f32 v49, v49, v252
  v_exp_f32 v49, v49
  v_sub_f32 v50, v50, v252
  v_exp_f32 v50, v50
  v_sub_f32 v51, v51, v252
  v_exp_f32 v51, v51
  v_sub_f32 v52, v52, v252
  v_exp_f32 v52, v52
  v_sub_f32 v53, v53, v252
  v_exp_f32 v53, v53
  v_sub_f32 v54, v54, v252
  v_exp_f32 v54, v54
  v_sub_f32 v55, v55, v252
  v_exp_f32 v55, v55
  v_sub_f32 v56, v56, v252
  v_exp_f32 v56, v56
  v_sub_f32 v57, v57, v252
  v_exp_f32 v57, v57
  v_sub_f32 v58, v58, v252
  v_exp_f32 v58, v58
  v_sub_f32 v59, v59, v252
  v_exp_f32 v59, v59
  v_sub_f32 v60, v60, v252
  v_exp_f32 v60, v60
  v_sub_f32 v61, v61, v252
  v_exp_f32 v61, v61
  v_sub_f32 v62, v62, v252
  v_exp_f32 v62, v62
  v_sub_f32 v63, v63, v252
  v_exp_f32 v63, v63
  v_add_f32 v233, v0, v1
  v_add_f32 v233, v233, v2
  v_add_f32 v233, v233, v3
  v_add_f32 v233, v233, v4
  v_add_f32 v233, v233, v5
  v_add_f32 v233, v233, v6
  v_add_f32 v233, v233, v7
  v_add_f32 v233, v233, v8
  v_add_f32 v233, v233, v9
  v_add_f32 v233, v233, v10
  v_add_f32 v233, v233, v11
  v_add_f32 v233, v233, v12
  v_add_f32 v233, v233, v13
  v_add_f32 v233, v233, v14
  v_add_f32 v233, v233, v15
  v_add_f32 v233, v233, v16
  v_add_f32 v233, v233, v17
  v_add_f32 v233, v233, v18
  v_add_f32 v233, v233, v19
  v_add_f32 v233, v233, v20
  v_add_f32 v233, v233, v21
  v_add_f32 v233, v233, v22
  v_add_f32 v233, v233, v23
  v_add_f32 v233, v233, v24
  v_add_f32 v233, v233, v25
  v_add_f32 v233, v233, v26
  v_add_f32 v233, v233, v27
  v_add_f32 v233, v233, v28
  v_add_f32 v233, v233, v29
  v_add_f32 v233, v233, v30
  v_add_f32 v233, v233, v31
  v_add_f32 v233, v233, v32
  v_add_f32 v233, v233, v33
  v_add_f32 v233, v233, v34
  v_add_f32 v233, v233, v35
  v_add_f32 v233, v233, v36
  v_add_f32 v233, v233, v37
  v_add_f32 v233, v233, v38
  v_add_f32 v233, v233, v39
  v_add_f32 v233, v233, v40
  v_add_f32 v233, v233, v41
  v_add_f32 v233, v233, v42
  v_add_f32 v233, v233, v43
  v_add_f32 v233, v233, v44
  v_add_f32 v233, v233, v45
  v_add_f32 v233, v233, v46
  v_add_f32 v233, v233, v47
  v_add_f32 v233, v233, v48
  v_add_f32 v233, v233, v49
  v_add_f32 v233, v233, v50
  v_add_f32 v233, v233, v51
  v_add_f32 v233, v233, v52
  v_add_f32 v233, v233, v53
  v_add_f32 v233, v233, v54
  v_add_f32 v233, v233, v55
  v_add_f32 v233, v233, v56
  v_add_f32 v233, v233, v57
  v_add_f32 v233, v233, v58
  v_add_f32 v233, v233, v59
  v_add_f32 v233, v233, v60
  v_add_f32 v233, v233, v61
  v_add_f32 v233, v233, v62
  v_add_f32 v233, v233, v63
  v_mov_b32 v235, v233
  s_nop 1
  v_permlane32_swap_b32 v235, v233
  v_add_f32 v233, v233, v235
  ds_write_b32 v228, v233 offset:0
  s_waitcnt lgkmcnt(0)
  s_barrier
  ds_read_b128 v[236:239], v229 offset:0
  s_waitcnt lgkmcnt(0)
  v_add_f32 v242, v236, v237
  v_add_f32 v238, v238, v239
  v_add_f32 v242, v242, v238
  v_rcp_f32 v240, v242
  s_nop 0
  v_mul_f32 v0, v0, v240
  v_mul_f32 v1, v1, v240
  v_cvt_pk_bf16_f32 v0, v0, v1
  v_mul_f32 v2, v2, v240
  v_mul_f32 v3, v3, v240
  v_cvt_pk_bf16_f32 v1, v2, v3
  v_mul_f32 v4, v4, v240
  v_mul_f32 v5, v5, v240
  v_cvt_pk_bf16_f32 v2, v4, v5
  v_mul_f32 v6, v6, v240
  v_mul_f32 v7, v7, v240
  v_cvt_pk_bf16_f32 v3, v6, v7
  ds_write_b128 v224, v[0:3] offset:0
  v_mul_f32 v8, v8, v240
  v_mul_f32 v9, v9, v240
  v_cvt_pk_bf16_f32 v8, v8, v9
  v_mul_f32 v10, v10, v240
  v_mul_f32 v11, v11, v240
  v_cvt_pk_bf16_f32 v9, v10, v11
  v_mul_f32 v12, v12, v240
  v_mul_f32 v13, v13, v240
  v_cvt_pk_bf16_f32 v10, v12, v13
  v_mul_f32 v14, v14, v240
  v_mul_f32 v15, v15, v240
  v_cvt_pk_bf16_f32 v11, v14, v15
  ds_write_b128 v224, v[8:11] offset:1024
  v_mul_f32 v16, v16, v240
  v_mul_f32 v17, v17, v240
  v_cvt_pk_bf16_f32 v16, v16, v17
  v_mul_f32 v18, v18, v240
  v_mul_f32 v19, v19, v240
  v_cvt_pk_bf16_f32 v17, v18, v19
  v_mul_f32 v20, v20, v240
  v_mul_f32 v21, v21, v240
  v_cvt_pk_bf16_f32 v18, v20, v21
  v_mul_f32 v22, v22, v240
  v_mul_f32 v23, v23, v240
  v_cvt_pk_bf16_f32 v19, v22, v23
  ds_write_b128 v224, v[16:19] offset:2048
  v_mul_f32 v24, v24, v240
  v_mul_f32 v25, v25, v240
  v_cvt_pk_bf16_f32 v24, v24, v25
  v_mul_f32 v26, v26, v240
  v_mul_f32 v27, v27, v240
  v_cvt_pk_bf16_f32 v25, v26, v27
  v_mul_f32 v28, v28, v240
  v_mul_f32 v29, v29, v240
  v_cvt_pk_bf16_f32 v26, v28, v29
  v_mul_f32 v30, v30, v240
  v_mul_f32 v31, v31, v240
  v_cvt_pk_bf16_f32 v27, v30, v31
  ds_write_b128 v224, v[24:27] offset:3072
  v_mul_f32 v32, v32, v240
  v_mul_f32 v33, v33, v240
  v_cvt_pk_bf16_f32 v32, v32, v33
  v_mul_f32 v34, v34, v240
  v_mul_f32 v35, v35, v240
  v_cvt_pk_bf16_f32 v33, v34, v35
  v_mul_f32 v36, v36, v240
  v_mul_f32 v37, v37, v240
  v_cvt_pk_bf16_f32 v34, v36, v37
  v_mul_f32 v38, v38, v240
  v_mul_f32 v39, v39, v240
  v_cvt_pk_bf16_f32 v35, v38, v39
  ds_write_b128 v224, v[32:35] offset:4096
  v_mul_f32 v40, v40, v240
  v_mul_f32 v41, v41, v240
  v_cvt_pk_bf16_f32 v40, v40, v41
  v_mul_f32 v42, v42, v240
  v_mul_f32 v43, v43, v240
  v_cvt_pk_bf16_f32 v41, v42, v43
  v_mul_f32 v44, v44, v240
  v_mul_f32 v45, v45, v240
  v_cvt_pk_bf16_f32 v42, v44, v45
  v_mul_f32 v46, v46, v240
  v_mul_f32 v47, v47, v240
  v_cvt_pk_bf16_f32 v43, v46, v47
  ds_write_b128 v224, v[40:43] offset:5120
  v_mul_f32 v48, v48, v240
  v_mul_f32 v49, v49, v240
  v_cvt_pk_bf16_f32 v48, v48, v49
  v_mul_f32 v50, v50, v240
  v_mul_f32 v51, v51, v240
  v_cvt_pk_bf16_f32 v49, v50, v51
  v_mul_f32 v52, v52, v240
  v_mul_f32 v53, v53, v240
  v_cvt_pk_bf16_f32 v50, v52, v53
  v_mul_f32 v54, v54, v240
  v_mul_f32 v55, v55, v240
  v_cvt_pk_bf16_f32 v51, v54, v55
  ds_write_b128 v224, v[48:51] offset:6144
  v_mul_f32 v56, v56, v240
  v_mul_f32 v57, v57, v240
  v_cvt_pk_bf16_f32 v56, v56, v57
  v_mul_f32 v58, v58, v240
  v_mul_f32 v59, v59, v240
  v_cvt_pk_bf16_f32 v57, v58, v59
  v_mul_f32 v60, v60, v240
  v_mul_f32 v61, v61, v240
  v_cvt_pk_bf16_f32 v58, v60, v61
  v_mul_f32 v62, v62, v240
  v_mul_f32 v63, v63, v240
  v_cvt_pk_bf16_f32 v59, v62, v63
  ds_write_b128 v224, v[56:59] offset:7168
  s_waitcnt lgkmcnt(0)
  s_barrier
  v_mfma_f32_32x32x16_bf16 v[192:207], a[128:131], v[0:3], 0
  v_mfma_f32_32x32x16_bf16 v[192:207], a[132:135], v[8:11], v[192:207]
  v_mfma_f32_32x32x16_bf16 v[192:207], a[136:139], v[16:19], v[192:207]
  v_mfma_f32_32x32x16_bf16 v[192:207], a[140:143], v[24:27], v[192:207]
  v_mfma_f32_32x32x16_bf16 v[192:207], a[144:147], v[32:35], v[192:207]
  v_mfma_f32_32x32x16_bf16 v[192:207], a[148:151], v[40:43], v[192:207]
  v_mfma_f32_32x32x16_bf16 v[192:207], a[152:155], v[48:51], v[192:207]
  v_mfma_f32_32x32x16_bf16 v[192:207], a[156:159], v[56:59], v[192:207]
  ds_read_b128 v[160:163], v225 offset:0
  ds_read_b128 v[164:167], v225 offset:1024
  ds_read_b128 v[168:171], v225 offset:2048
  ds_read_b128 v[172:175], v225 offset:3072
  ds_read_b128 v[176:179], v225 offset:4096
  ds_read_b128 v[180:183], v225 offset:5120
  ds_read_b128 v[184:187], v225 offset:6144
  ds_read_b128 v[188:191], v225 offset:7168
  s_waitcnt lgkmcnt(7)
  v_mfma_f32_32x32x16_bf16 v[192:207], a[160:163], v[160:163], v[192:207]
  s_waitcnt lgkmcnt(6)
  v_mfma_f32_32x32x16_bf16 v[192:207], a[164:167], v[164:167], v[192:207]
  s_waitcnt lgkmcnt(5)
  v_mfma_f32_32x32x16_bf16 v[192:207], a[168:171], v[168:171], v[192:207]
  s_waitcnt lgkmcnt(4)
  v_mfma_f32_32x32x16_bf16 v[192:207], a[172:175], v[172:175], v[192:207]
  s_waitcnt lgkmcnt(3)
  v_mfma_f32_32x32x16_bf16 v[192:207], a[176:179], v[176:179], v[192:207]
  s_waitcnt lgkmcnt(2)
  v_mfma_f32_32x32x16_bf16 v[192:207], a[180:183], v[180:183], v[192:207]
  s_waitcnt lgkmcnt(1)
  v_mfma_f32_32x32x16_bf16 v[192:207], a[184:187], v[184:187], v[192:207]
  s_waitcnt lgkmcnt(0)
  v_mfma_f32_32x32x16_bf16 v[192:207], a[188:191], v[188:191], v[192:207]
  ds_read_b128 v[160:163], v226 offset:0
  ds_read_b128 v[164:167], v226 offset:1024
  ds_read_b128 v[168:171], v226 offset:2048
  ds_read_b128 v[172:175], v226 offset:3072
  ds_read_b128 v[176:179], v226 offset:4096
  ds_read_b128 v[180:183], v226 offset:5120
  ds_read_b128 v[184:187], v226 offset:6144
  ds_read_b128 v[188:191], v226 offset:7168
  s_waitcnt lgkmcnt(7)
  v_mfma_f32_32x32x16_bf16 v[192:207], a[192:195], v[160:163], v[192:207]
  s_waitcnt lgkmcnt(6)
  v_mfma_f32_32x32x16_bf16 v[192:207], a[196:199], v[164:167], v[192:207]
  s_waitcnt lgkmcnt(5)
  v_mfma_f32_32x32x16_bf16 v[192:207], a[200:203], v[168:171], v[192:207]
  s_waitcnt lgkmcnt(4)
  v_mfma_f32_32x32x16_bf16 v[192:207], a[204:207], v[172:175], v[192:207]
  s_waitcnt lgkmcnt(3)
  v_mfma_f32_32x32x16_bf16 v[192:207], a[208:211], v[176:179], v[192:207]
  s_waitcnt lgkmcnt(2)
  v_mfma_f32_32x32x16_bf16 v[192:207], a[212:215], v[180:183], v[192:207]
  s_waitcnt lgkmcnt(1)
  v_mfma_f32_32x32x16_bf16 v[192:207], a[216:219], v[184:187], v[192:207]
  s_waitcnt lgkmcnt(0)
  v_mfma_f32_32x32x16_bf16 v[192:207], a[220:223], v[188:191], v[192:207]
  ds_read_b128 v[160:163], v227 offset:0
  ds_read_b128 v[164:167], v227 offset:1024
  ds_read_b128 v[168:171], v227 offset:2048
  ds_read_b128 v[172:175], v227 offset:3072
  ds_read_b128 v[176:179], v227 offset:4096
  ds_read_b128 v[180:183], v227 offset:5120
  ds_read_b128 v[184:187], v227 offset:6144
  ds_read_b128 v[188:191], v227 offset:7168
  s_waitcnt lgkmcnt(7)
  v_mfma_f32_32x32x16_bf16 v[192:207], a[224:227], v[160:163], v[192:207]
  s_waitcnt lgkmcnt(6)
  v_mfma_f32_32x32x16_bf16 v[192:207], a[228:231], v[164:167], v[192:207]
  s_waitcnt lgkmcnt(5)
  v_mfma_f32_32x32x16_bf16 v[192:207], a[232:235], v[168:171], v[192:207]
  s_waitcnt lgkmcnt(4)
  v_mfma_f32_32x32x16_bf16 v[192:207], a[236:239], v[172:175], v[192:207]
  s_waitcnt lgkmcnt(3)
  v_mfma_f32_32x32x16_bf16 v[192:207], a[240:243], v[176:179], v[192:207]
  s_waitcnt lgkmcnt(2)
  v_mfma_f32_32x32x16_bf16 v[192:207], a[244:247], v[180:183], v[192:207]
  s_waitcnt lgkmcnt(1)
  v_mfma_f32_32x32x16_bf16 v[192:207], a[248:251], v[184:187], v[192:207]
  s_waitcnt lgkmcnt(0)
  v_mfma_f32_32x32x16_bf16 v[192:207], a[252:255], v[188:191], v[192:207]
  s_nop 11
  v_cvt_pk_bf16_f32 v208, v192, v193
  v_cvt_pk_bf16_f32 v209, v194, v195
  v_cvt_pk_bf16_f32 v210, v196, v197
  v_cvt_pk_bf16_f32 v211, v198, v199
  v_cvt_pk_bf16_f32 v212, v200, v201
  v_cvt_pk_bf16_f32 v213, v202, v203
  v_cvt_pk_bf16_f32 v214, v204, v205
  v_cvt_pk_bf16_f32 v215, v206, v207
  buffer_store_dwordx4 v[208:211], v230, s[16:19], s21 offen sc1
  buffer_store_dwordx4 v[212:215], v230, s[16:19], s21 offen offset:32 sc1
  s_waitcnt vmcnt(0) lgkmcnt(0)
  s_barrier
  s_add_u32 s21, s21, 8192
  s_sub_u32 s23, s23, 1
  s_cmp_lg_u32 s23, 0
  s_cbranch_scc1 L_slow
L_done:
L_end:
  s_endpgm

.section .rodata,"a"
.p2align 6
.amdhsa_kernel standalone__gqa_softmax__near_ridge_kernel
  .amdhsa_next_free_vgpr 512
  .amdhsa_next_free_sgpr 102
  .amdhsa_accum_offset 256
  .amdhsa_group_segment_fixed_size 0
  .amdhsa_kernarg_size 48
  .amdhsa_user_sgpr_count 2
  .amdhsa_user_sgpr_kernarg_segment_ptr 1
  .amdhsa_system_sgpr_workgroup_id_x 1
  .amdhsa_float_denorm_mode_32 3
.end_amdhsa_kernel
```
